```python
import torch

def _softmax(x, axis=-1):
    return torch.softmax(x, dim=axis)
def _gelu(x):
    return torch.nn.functional.gelu(x, approximate="tanh")
def _silu(x):
    return torch.nn.functional.silu(x)
def _sigmoid(x):
    return torch.sigmoid(x)
def _layernorm(x, axis=-1, eps=1e-5):
    m = x.mean(dim=axis, keepdim=True)
    v = x.var(dim=axis, keepdim=True, unbiased=False)
    return (x - m) / torch.sqrt(v + eps)
def _scatter_add(tgt, idx, src, axis=0):
    return tgt.clone().index_add_(axis, idx, src)
def _segment_sum(src, seg, n):
    out = torch.zeros((n,) + src.shape[1:], dtype=src.dtype)
    return out.index_add_(0, seg, src)
def _pad(x, pw):
    flat = tuple(v for pair in reversed(pw) for v in pair)
    return torch.nn.functional.pad(x, flat)

kernel_name = 'recurrent_scan__gqa_block_cached__glu_gated_bilinear__decode'

def setup_inputs():

    _w = (lambda a: (lambda t: t.to(torch.bfloat16) if t.is_floating_point() else t)(torch.as_tensor(a)))
    def _A_setup():
        B, Sq, D = 2, 1, 640
        Hq, Hkv, Sk, Dh = 32, 32, 4096, 192
        assert Hq % Hkv == 0, (Hq, Hkv)
        return {
            "x": _w((lambda *s: torch.randn(*s, dtype=torch.bfloat16) * 0.2)(B, Sq, D)),
            "k_cache": _w((lambda *s: torch.randn(*s, dtype=torch.bfloat16) * 1.6)(B, Hkv, Sk, Dh)),
            "v_cache": _w((lambda *s: torch.randn(*s, dtype=torch.bfloat16) * 1.6)(B, Hkv, Sk, Dh)),
            "wq": _w((lambda *s: torch.randn(*s, dtype=torch.bfloat16) * 1.6)(D, Hq * Dh) * (D ** -0.5)),
            "wo": _w((lambda *s: torch.randn(*s, dtype=torch.bfloat16) * 1.6)(Hq * Dh, D) * ((Hq * Dh) ** -0.5)),
        }
    _A_in = _A_setup()

    def _B_setup():
        B, S, D, F = 2, 1, 640, 1536
        return {
            "x": _w((lambda *s: torch.randn(*s, dtype=torch.bfloat16) * 0.2)(B, S, D)),
            "w_gate": _w((lambda *s: torch.randn(*s, dtype=torch.bfloat16) * 0.8)(D, F) * (D ** -0.5)),
            "w_up": _w((lambda *s: torch.randn(*s, dtype=torch.bfloat16) * 0.8)(D, F) * (D ** -0.5)),
            "w_down": _w((lambda *s: torch.randn(*s, dtype=torch.bfloat16) * 0.8)(F, D) * (F ** -0.5)),
        }
    _B_in = _B_setup()

    return {
        "A_x": _A_in["x"],
        "A_k_cache": _A_in["k_cache"],
        "A_v_cache": _A_in["v_cache"],
        "A_wq": _A_in["wq"],
        "A_wo": _A_in["wo"],
        "B_x": _B_in["x"],
        "B_w_gate": _B_in["w_gate"],
        "B_w_up": _B_in["w_up"],
        "B_w_down": _B_in["w_down"],
    }

def reference(A_x, A_k_cache, A_v_cache, A_wq, A_wo, B_x, B_w_gate, B_w_up, B_w_down):
    def _A_ref(x, k_cache, v_cache, wq, wo):
        B, Sq, D = x.shape
        Hq, Dh = 32, 192
        Hkv = k_cache.shape[1]
        rep = Hq // Hkv
        q = (lambda x, *d: x.permute(*d))((x @ wq).reshape(B, Sq, Hq, Dh), 0, 2, 1, 3)
        k = (lambda x, n, axis: torch.repeat_interleave(x, n, dim=axis))(k_cache, rep, axis=1)
        v = (lambda x, n, axis: torch.repeat_interleave(x, n, dim=axis))(v_cache, rep, axis=1)
        scores = torch.einsum("bhqd,bhkd->bhqk", q, k) * (Dh ** -0.5)
        p = _softmax(scores, axis=-1)
        o = torch.einsum("bhqk,bhkd->bhqd", p, v)
        return (lambda x, *d: x.permute(*d))(o, 0, 2, 1, 3).reshape(B, Sq, Hq * Dh) @ wo

    def _B_ref(x, w_gate, w_up, w_down):
        g = torch.einsum("bsd,df->bsf", x, w_gate)
        u = torch.einsum("bsd,df->bsf", x, w_up)
        h = g * u
        return torch.einsum("bsf,fd->bsd", h, w_down)

    x = A_x
    xn = _layernorm(x, axis=-1)
    s = _A_ref(xn, A_k_cache, A_v_cache, A_wq, A_wo)
    g = _silu(_B_ref(xn, B_w_gate, B_w_up, B_w_down))
    return x + s * g
```

```asm
; @launch grid=(256,1,1) block=(512,1,1) lds=42240
.amdgcn_target "amdgcn-amd-amdhsa--gfx950"
.text
.globl recurrent_scan__gqa_block_cached__glu_gated_bilinear__decode_kernel
.p2align 8
.type recurrent_scan__gqa_block_cached__glu_gated_bilinear__decode_kernel,@function
recurrent_scan__gqa_block_cached__glu_gated_bilinear__decode_kernel:
  s_cmp_ge_u32 s2, 256
  s_cbranch_scc1 L_end
  s_load_dwordx16 s[4:19], s[0:1], 0
  s_load_dwordx8 s[20:27], s[0:1], 64
  v_lshrrev_b32 v1, 6, v0
  v_and_b32 v0, 63, v0
  v_readfirstlane_b32 s3, v1
  s_and_b32 s48, s2, 7
  s_lshr_b32 s49, s2, 3
  s_lshr_b32 s28, s49, 3
  s_lshl2_add_u32 s28, s48, s28
  s_and_b32 s29, s49, 7
  s_lshr_b32 s30, s29, 2
  s_cmp_lt_u32 s3, 4
  s_cbranch_scc1 L_HELP
  s_sub_u32 s55, s3, 4
  v_lshrrev_b32 v4, 5, v0
  v_bfe_u32 v5, v0, 2, 2
  v_lshl_add_u32 v4, v4, 2, v5
  v_mul_u32_u24 v1, 384, v4
  v_and_b32 v5, 3, v0
  v_bfe_u32 v6, v0, 4, 1
  v_lshl_add_u32 v5, v6, 2, v5
  v_lshlrev_b32 v3, 4, v5
  v_add_u32 v1, v1, v3
  s_lshl_b32 s48, s30, 5
  s_add_u32 s48, s48, s28
  s_lshl_b32 s48, s48, 2
  s_and_b32 s49, s29, 3
  s_add_u32 s48, s48, s49
  s_lshl_b32 s48, s48, 2
  s_add_u32 s48, s48, s55
  s_mul_i32 s52, s48, 98304
  s_mov_b32 s53, s52
  s_mov_b32 s38, 100663296
  s_mov_b32 s39, 0x20000
  s_waitcnt lgkmcnt(0)
  s_mov_b32 s36, s6
  s_mov_b32 s37, s7
  buffer_load_dwordx4 v[84:87], v1, s[36:39], s52 offen offset:0 nt
  buffer_load_dwordx4 v[88:91], v1, s[36:39], s52 offen offset:128 nt
  buffer_load_dwordx4 v[92:95], v1, s[36:39], s52 offen offset:256 nt
  buffer_load_dwordx4 v[96:99], v1, s[36:39], s52 offen offset:3072 nt
  buffer_load_dwordx4 v[100:103], v1, s[36:39], s52 offen offset:3200 nt
L_STREAM:
  s_load_dword s31, s[26:27], 0
  s_waitcnt vmcnt(4)
  buffer_load_dwordx4 v[104:107], v1, s[36:39], s52 offen offset:3328 nt
  s_add_u32 s52, s52, 6144
  s_waitcnt vmcnt(4)
  buffer_load_dwordx4 v[108:111], v1, s[36:39], s52 offen offset:0 nt
  s_waitcnt vmcnt(4)
  buffer_load_dwordx4 v[112:115], v1, s[36:39], s52 offen offset:128 nt
  s_waitcnt vmcnt(4)
  buffer_load_dwordx4 v[116:119], v1, s[36:39], s52 offen offset:256 nt
  s_waitcnt vmcnt(4)
  buffer_load_dwordx4 v[120:123], v1, s[36:39], s52 offen offset:3072 nt
  s_waitcnt vmcnt(4)
  buffer_load_dwordx4 v[124:127], v1, s[36:39], s52 offen offset:3200 nt
  s_waitcnt vmcnt(4)
  buffer_load_dwordx4 v[128:131], v1, s[36:39], s52 offen offset:3328 nt
  s_add_u32 s52, s52, 6144
  s_mov_b32 s40, s8
  s_mov_b32 s41, s9
  s_mov_b32 s42, 100663296
  s_mov_b32 s43, 0x20000
  s_mov_b32 s44, s12
  s_mov_b32 s45, s13
  s_mov_b32 s46, 7864320
  s_mov_b32 s47, 0x20000
  s_mov_b32 s32, s26
  s_mov_b32 s33, s27
  s_mov_b32 s34, 402653184
  s_mov_b32 s35, 0x20000
  s_and_b32 s48, s2, 7
  s_lshr_b32 s49, s2, 3
  s_lshr_b32 s58, s49, 3
  s_lshl2_add_u32 s58, s48, s58
  s_and_b32 s59, s49, 7
  v_bfe_u32 v4, v0, 3, 1
  v_lshrrev_b32 v5, 4, v0
  v_lshl_add_u32 v4, v4, 3, v5
  v_mul_u32_u24 v2, 384, v4
  v_and_b32 v5, 7, v0
  v_lshl_add_u32 v2, v5, 4, v2
  v_mul_u32_u24 v76, 6554, v0
  v_lshrrev_b32 v76, 16, v76
  v_mul_u32_u24 v5, 10, v76
  v_sub_u32 v5, v0, v5
  v_mul_u32_u24 v76, 1280, v76
  v_lshl_add_u32 v76, v5, 4, v76
  s_mul_i32 s54, s58, 192
  s_mul_i32 s48, s55, 48
  s_add_u32 s54, s54, s48
  s_mul_i32 s54, s54, 1280
  s_mul_i32 s48, s59, 160
  s_add_u32 s54, s54, s48
  s_mul_i32 s56, s55, 7680
  s_add_u32 s56, s56, 11520
  v_lshrrev_b32 v5, 5, v0
  v_mul_u32_u24 v77, 768, v5
  v_and_b32 v5, 7, v0
  v_lshl_add_u32 v77, v5, 5, v77
  v_bfe_u32 v5, v0, 4, 1
  v_lshl_add_u32 v77, v5, 4, v77
  s_mul_i32 s48, s55, 1536
  v_add_u32 v77, s48, v77
  v_and_b32 v78, 1, v0
  v_lshlrev_b32 v78, 4, v78
  s_mov_b32 s48, 0xffff
  v_lshlrev_b32_e64 v78, v78, s48
  s_mov_b32 s48, 0x03030303
  s_mov_b32 s49, s48
  v_cndmask_b32_e64 v4, 0, v78, s[48:49]
  s_mov_b32 s48, 0x0c0c0c0c
  s_mov_b32 s49, s48
  v_cndmask_b32_e64 v5, 0, v78, s[48:49]
  s_mov_b32 s48, 0x30303030
  s_mov_b32 s49, s48
  v_cndmask_b32_e64 v6, 0, v78, s[48:49]
  s_mov_b32 s48, 0xc0c0c0c0
  s_mov_b32 s49, s48
  v_cndmask_b32_e64 v7, 0, v78, s[48:49]
  v_mov_b32 v28, 0
  v_mov_b32 v29, 0
  v_mov_b32 v30, 0
  v_mov_b32 v31, 0
  v_mov_b32 v32, 0
  v_mov_b32 v33, 0
  v_mov_b32 v34, 0
  v_mov_b32 v35, 0
  v_mov_b32 v36, 0
  v_mov_b32 v37, 0
  v_mov_b32 v38, 0
  v_mov_b32 v39, 0
  v_mov_b32 v40, 0
  v_mov_b32 v41, 0
  v_mov_b32 v42, 0
  v_mov_b32 v43, 0
  v_mov_b32 v44, 0
  v_mov_b32 v45, 0
  v_mov_b32 v46, 0
  v_mov_b32 v47, 0
  v_mov_b32 v48, 0
  v_mov_b32 v49, 0
  v_mov_b32 v50, 0
  v_mov_b32 v51, 0
  v_mov_b32 v79, 0xff800000
  s_waitcnt vmcnt(4)
  buffer_load_dwordx4 v[132:135], v1, s[36:39], s52 offen offset:0 nt
  s_waitcnt vmcnt(4)
  buffer_load_dwordx4 v[136:139], v1, s[36:39], s52 offen offset:128 nt
  s_waitcnt vmcnt(4)
  buffer_load_dwordx4 v[140:143], v1, s[36:39], s52 offen offset:256 nt
  s_waitcnt vmcnt(4)
  buffer_load_dwordx4 v[144:147], v1, s[36:39], s52 offen offset:3072 nt
  s_waitcnt vmcnt(4)
  buffer_load_dwordx4 v[148:151], v1, s[36:39], s52 offen offset:3200 nt
  s_waitcnt vmcnt(4)
  buffer_load_dwordx4 v[152:155], v1, s[36:39], s52 offen offset:3328 nt
  s_add_u32 s52, s52, 6144
  s_waitcnt vmcnt(4)
  buffer_load_dwordx4 v[156:159], v1, s[36:39], s52 offen offset:0 nt
  s_waitcnt vmcnt(4)
  buffer_load_dwordx4 v[160:163], v1, s[36:39], s52 offen offset:128 nt
  s_waitcnt vmcnt(4)
  buffer_load_dwordx4 v[164:167], v1, s[36:39], s52 offen offset:256 nt
  s_waitcnt vmcnt(4)
  buffer_load_dwordx4 v[168:171], v1, s[36:39], s52 offen offset:3072 nt
  s_waitcnt vmcnt(4)
  buffer_load_dwordx4 v[172:175], v1, s[36:39], s52 offen offset:3200 nt
  s_waitcnt vmcnt(4)
  buffer_load_dwordx4 v[176:179], v1, s[36:39], s52 offen offset:3328 nt
  s_add_u32 s52, s52, 6144
  s_waitcnt vmcnt(4)
  buffer_load_dwordx4 v[180:183], v1, s[36:39], s52 offen offset:0 nt
  s_waitcnt vmcnt(4)
  buffer_load_dwordx4 v[184:187], v1, s[36:39], s52 offen offset:128 nt
  s_waitcnt vmcnt(4)
  buffer_load_dwordx4 v[188:191], v1, s[36:39], s52 offen offset:256 nt
  s_waitcnt vmcnt(4)
  buffer_load_dwordx4 v[192:195], v1, s[36:39], s52 offen offset:3072 nt
  s_waitcnt vmcnt(4)
  buffer_load_dwordx4 v[196:199], v1, s[36:39], s52 offen offset:3200 nt
  s_waitcnt vmcnt(4)
  buffer_load_dwordx4 v[200:203], v1, s[36:39], s52 offen offset:3328 nt
  s_add_u32 s52, s52, 6144
  s_waitcnt vmcnt(4)
  buffer_load_dwordx4 v[204:207], v1, s[36:39], s52 offen offset:0 nt
  s_waitcnt vmcnt(4)
  buffer_load_dwordx4 v[208:211], v1, s[36:39], s52 offen offset:128 nt
  s_waitcnt vmcnt(4)
  buffer_load_dwordx4 v[212:215], v1, s[36:39], s52 offen offset:256 nt
  s_waitcnt vmcnt(4)
  buffer_load_dwordx4 v[216:219], v1, s[36:39], s52 offen offset:3072 nt
  s_waitcnt vmcnt(4)
  buffer_load_dwordx4 v[220:223], v1, s[36:39], s52 offen offset:3200 nt
  s_waitcnt vmcnt(4)
  buffer_load_dwordx4 v[224:227], v1, s[36:39], s52 offen offset:3328 nt
  s_add_u32 s52, s52, 6144
  s_waitcnt vmcnt(4)
  buffer_load_dwordx4 v[228:231], v1, s[36:39], s52 offen offset:0 nt
  s_waitcnt vmcnt(4)
  buffer_load_dwordx4 v[232:235], v1, s[36:39], s52 offen offset:128 nt
  s_waitcnt vmcnt(4)
  buffer_load_dwordx4 v[236:239], v1, s[36:39], s52 offen offset:256 nt
  s_waitcnt vmcnt(4)
  buffer_load_dwordx4 v[240:243], v1, s[36:39], s52 offen offset:3072 nt
  s_waitcnt vmcnt(4)
  buffer_load_dwordx4 v[244:247], v1, s[36:39], s52 offen offset:3200 nt
  s_waitcnt vmcnt(4)
  buffer_load_dwordx4 v[248:251], v1, s[36:39], s52 offen offset:3328 nt
  s_add_u32 s52, s52, 6144
  s_barrier
  s_mov_b32 exec_lo, 0x000f000f
  s_mov_b32 exec_hi, 0x00f000f0
  ds_read_b128 v[28:31], v3 offset:2048
  ds_read_b128 v[32:35], v3 offset:2176
  ds_read_b128 v[36:39], v3 offset:2304
  s_mov_b32 exec_lo, 0x0f000f00
  s_mov_b32 exec_hi, 0xf000f000
  ds_read_b128 v[40:43], v3 offset:2048
  ds_read_b128 v[44:47], v3 offset:2176
  ds_read_b128 v[48:51], v3 offset:2304
  s_mov_b64 exec, -1
  s_waitcnt lgkmcnt(0)
  s_add_u32 s31, s31, 0x9e3779b1
  v_mfma_f32_16x16x32_bf16 v[8:11], v[84:87], v[28:31], 0
  s_waitcnt vmcnt(4)
  buffer_load_dwordx4 v[84:87], v1, s[36:39], s52 offen offset:0 nt
  v_mfma_f32_16x16x32_bf16 v[8:11], v[88:91], v[32:35], v[8:11]
  s_waitcnt vmcnt(4)
  buffer_load_dwordx4 v[88:91], v1, s[36:39], s52 offen offset:128 nt
  v_mfma_f32_16x16x32_bf16 v[8:11], v[92:95], v[36:39], v[8:11]
  s_waitcnt vmcnt(4)
  buffer_load_dwordx4 v[92:95], v1, s[36:39], s52 offen offset:256 nt
  v_mfma_f32_16x16x32_bf16 v[8:11], v[96:99], v[40:43], v[8:11]
  s_waitcnt vmcnt(4)
  buffer_load_dwordx4 v[96:99], v1, s[36:39], s52 offen offset:3072 nt
  v_mfma_f32_16x16x32_bf16 v[8:11], v[100:103], v[44:47], v[8:11]
  s_waitcnt vmcnt(4)
  buffer_load_dwordx4 v[100:103], v1, s[36:39], s52 offen offset:3200 nt
  v_mfma_f32_16x16x32_bf16 v[8:11], v[104:107], v[48:51], v[8:11]
  s_waitcnt vmcnt(4)
  buffer_load_dwordx4 v[104:107], v1, s[36:39], s52 offen offset:3328 nt
  s_add_u32 s52, s52, 6144
  v_mfma_f32_16x16x32_bf16 v[12:15], v[108:111], v[28:31], 0
  v_mfma_f32_16x16x32_bf16 v[12:15], v[112:115], v[32:35], v[12:15]
  s_waitcnt vmcnt(4)
  buffer_load_dwordx4 v[108:111], v1, s[36:39], s52 offen offset:0 nt
  v_mfma_f32_16x16x32_bf16 v[12:15], v[116:119], v[36:39], v[12:15]
  v_mfma_f32_16x16x32_bf16 v[12:15], v[120:123], v[40:43], v[12:15]
  s_waitcnt vmcnt(4)
  buffer_load_dwordx4 v[112:115], v1, s[36:39], s52 offen offset:128 nt
  v_mfma_f32_16x16x32_bf16 v[12:15], v[124:127], v[44:47], v[12:15]
  v_mfma_f32_16x16x32_bf16 v[12:15], v[128:131], v[48:51], v[12:15]
  s_waitcnt vmcnt(4)
  buffer_load_dwordx4 v[116:119], v1, s[36:39], s52 offen offset:256 nt
  s_nop 1
  v_mov_b32_dpp v52, v8 quad_perm:[0,0,0,0] row_mask:0xf bank_mask:0xf
  v_add_f32_dpp v52, v9, v52 quad_perm:[1,1,1,1] row_mask:0xf bank_mask:0xf
  v_add_f32_dpp v52, v10, v52 quad_perm:[2,2,2,2] row_mask:0xf bank_mask:0xf
  v_add_f32_dpp v52, v11, v52 quad_perm:[3,3,3,3] row_mask:0xf bank_mask:0xf
  v_cvt_pk_bf16_f32 v52, v52, v52
  v_and_b32 v52, 0xffff0000, v52
  v_mul_f32 v52, 0x3d93cd3a, v52
  v_cvt_pk_bf16_f32 v52, v52, v52
  v_and_b32 v52, 0xffff0000, v52
  v_max_f32 v79, v79, v52
  v_mfma_f32_16x16x32_bf16 v[8:11], v[132:135], v[28:31], 0
  v_mfma_f32_16x16x32_bf16 v[8:11], v[136:139], v[32:35], v[8:11]
  s_waitcnt vmcnt(4)
  buffer_load_dwordx4 v[120:123], v1, s[36:39], s52 offen offset:3072 nt
  v_mfma_f32_16x16x32_bf16 v[8:11], v[140:143], v[36:39], v[8:11]
  v_mfma_f32_16x16x32_bf16 v[8:11], v[144:147], v[40:43], v[8:11]
  s_waitcnt vmcnt(4)
  buffer_load_dwordx4 v[124:127], v1, s[36:39], s52 offen offset:3200 nt
  v_mfma_f32_16x16x32_bf16 v[8:11], v[148:151], v[44:47], v[8:11]
  v_mfma_f32_16x16x32_bf16 v[8:11], v[152:155], v[48:51], v[8:11]
  s_waitcnt vmcnt(4)
  buffer_load_dwordx4 v[128:131], v1, s[36:39], s52 offen offset:3328 nt
  s_add_u32 s52, s52, 6144
  s_nop 1
  v_mov_b32_dpp v53, v12 quad_perm:[0,0,0,0] row_mask:0xf bank_mask:0xf
  v_add_f32_dpp v53, v13, v53 quad_perm:[1,1,1,1] row_mask:0xf bank_mask:0xf
  v_add_f32_dpp v53, v14, v53 quad_perm:[2,2,2,2] row_mask:0xf bank_mask:0xf
  v_add_f32_dpp v53, v15, v53 quad_perm:[3,3,3,3] row_mask:0xf bank_mask:0xf
  v_cvt_pk_bf16_f32 v53, v53, v53
  v_and_b32 v53, 0xffff0000, v53
  v_mul_f32 v53, 0x3d93cd3a, v53
  v_cvt_pk_bf16_f32 v53, v53, v53
  v_and_b32 v53, 0xffff0000, v53
  v_max_f32 v79, v79, v53
  v_mfma_f32_16x16x32_bf16 v[12:15], v[156:159], v[28:31], 0
  v_mfma_f32_16x16x32_bf16 v[12:15], v[160:163], v[32:35], v[12:15]
  s_waitcnt vmcnt(4)
  buffer_load_dwordx4 v[132:135], v1, s[36:39], s52 offen offset:0 nt
  v_mfma_f32_16x16x32_bf16 v[12:15], v[164:167], v[36:39], v[12:15]
  v_mfma_f32_16x16x32_bf16 v[12:15], v[168:171], v[40:43], v[12:15]
  s_waitcnt vmcnt(4)
  buffer_load_dwordx4 v[136:139], v1, s[36:39], s52 offen offset:128 nt
  v_mfma_f32_16x16x32_bf16 v[12:15], v[172:175], v[44:47], v[12:15]
  v_mfma_f32_16x16x32_bf16 v[12:15], v[176:179], v[48:51], v[12:15]
  s_waitcnt vmcnt(4)
  buffer_load_dwordx4 v[140:143], v1, s[36:39], s52 offen offset:256 nt
  s_nop 1
  v_mov_b32_dpp v54, v8 quad_perm:[0,0,0,0] row_mask:0xf bank_mask:0xf
  v_add_f32_dpp v54, v9, v54 quad_perm:[1,1,1,1] row_mask:0xf bank_mask:0xf
  v_add_f32_dpp v54, v10, v54 quad_perm:[2,2,2,2] row_mask:0xf bank_mask:0xf
  v_add_f32_dpp v54, v11, v54 quad_perm:[3,3,3,3] row_mask:0xf bank_mask:0xf
  v_cvt_pk_bf16_f32 v54, v54, v54
  v_and_b32 v54, 0xffff0000, v54
  v_mul_f32 v54, 0x3d93cd3a, v54
  v_cvt_pk_bf16_f32 v54, v54, v54
  v_and_b32 v54, 0xffff0000, v54
  v_max_f32 v79, v79, v54
  v_mfma_f32_16x16x32_bf16 v[8:11], v[180:183], v[28:31], 0
  v_mfma_f32_16x16x32_bf16 v[8:11], v[184:187], v[32:35], v[8:11]
  s_waitcnt vmcnt(4)
  buffer_load_dwordx4 v[144:147], v1, s[36:39], s52 offen offset:3072 nt
  v_mfma_f32_16x16x32_bf16 v[8:11], v[188:191], v[36:39], v[8:11]
  v_mfma_f32_16x16x32_bf16 v[8:11], v[192:195], v[40:43], v[8:11]
  s_waitcnt vmcnt(4)
  buffer_load_dwordx4 v[148:151], v1, s[36:39], s52 offen offset:3200 nt
  v_mfma_f32_16x16x32_bf16 v[8:11], v[196:199], v[44:47], v[8:11]
  v_mfma_f32_16x16x32_bf16 v[8:11], v[200:203], v[48:51], v[8:11]
  s_waitcnt vmcnt(4)
  buffer_load_dwordx4 v[152:155], v1, s[36:39], s52 offen offset:3328 nt
  s_add_u32 s52, s52, 6144
  s_nop 1
  v_mov_b32_dpp v55, v12 quad_perm:[0,0,0,0] row_mask:0xf bank_mask:0xf
  v_add_f32_dpp v55, v13, v55 quad_perm:[1,1,1,1] row_mask:0xf bank_mask:0xf
  v_add_f32_dpp v55, v14, v55 quad_perm:[2,2,2,2] row_mask:0xf bank_mask:0xf
  v_add_f32_dpp v55, v15, v55 quad_perm:[3,3,3,3] row_mask:0xf bank_mask:0xf
  v_cvt_pk_bf16_f32 v55, v55, v55
  v_and_b32 v55, 0xffff0000, v55
  v_mul_f32 v55, 0x3d93cd3a, v55
  v_cvt_pk_bf16_f32 v55, v55, v55
  v_and_b32 v55, 0xffff0000, v55
  v_max_f32 v79, v79, v55
  v_mfma_f32_16x16x32_bf16 v[12:15], v[204:207], v[28:31], 0
  v_mfma_f32_16x16x32_bf16 v[12:15], v[208:211], v[32:35], v[12:15]
  s_waitcnt vmcnt(4)
  buffer_load_dwordx4 v[156:159], v1, s[36:39], s52 offen offset:0 nt
  v_mfma_f32_16x16x32_bf16 v[12:15], v[212:215], v[36:39], v[12:15]
  v_mfma_f32_16x16x32_bf16 v[12:15], v[216:219], v[40:43], v[12:15]
  s_waitcnt vmcnt(4)
  buffer_load_dwordx4 v[160:163], v1, s[36:39], s52 offen offset:128 nt
  v_mfma_f32_16x16x32_bf16 v[12:15], v[220:223], v[44:47], v[12:15]
  v_mfma_f32_16x16x32_bf16 v[12:15], v[224:227], v[48:51], v[12:15]
  s_waitcnt vmcnt(4)
  buffer_load_dwordx4 v[164:167], v1, s[36:39], s52 offen offset:256 nt
  s_nop 1
  v_mov_b32_dpp v56, v8 quad_perm:[0,0,0,0] row_mask:0xf bank_mask:0xf
  v_add_f32_dpp v56, v9, v56 quad_perm:[1,1,1,1] row_mask:0xf bank_mask:0xf
  v_add_f32_dpp v56, v10, v56 quad_perm:[2,2,2,2] row_mask:0xf bank_mask:0xf
  v_add_f32_dpp v56, v11, v56 quad_perm:[3,3,3,3] row_mask:0xf bank_mask:0xf
  v_cvt_pk_bf16_f32 v56, v56, v56
  v_and_b32 v56, 0xffff0000, v56
  v_mul_f32 v56, 0x3d93cd3a, v56
  v_cvt_pk_bf16_f32 v56, v56, v56
  v_and_b32 v56, 0xffff0000, v56
  v_max_f32 v79, v79, v56
  v_mfma_f32_16x16x32_bf16 v[8:11], v[228:231], v[28:31], 0
  v_mfma_f32_16x16x32_bf16 v[8:11], v[232:235], v[32:35], v[8:11]
  s_waitcnt vmcnt(4)
  buffer_load_dwordx4 v[168:171], v1, s[36:39], s52 offen offset:3072 nt
  v_mfma_f32_16x16x32_bf16 v[8:11], v[236:239], v[36:39], v[8:11]
  v_mfma_f32_16x16x32_bf16 v[8:11], v[240:243], v[40:43], v[8:11]
  s_waitcnt vmcnt(4)
  buffer_load_dwordx4 v[172:175], v1, s[36:39], s52 offen offset:3200 nt
  v_mfma_f32_16x16x32_bf16 v[8:11], v[244:247], v[44:47], v[8:11]
  v_mfma_f32_16x16x32_bf16 v[8:11], v[248:251], v[48:51], v[8:11]
  s_waitcnt vmcnt(4)
  buffer_load_dwordx4 v[176:179], v1, s[36:39], s52 offen offset:3328 nt
  s_add_u32 s52, s52, 6144
  s_nop 1
  v_mov_b32_dpp v57, v12 quad_perm:[0,0,0,0] row_mask:0xf bank_mask:0xf
  v_add_f32_dpp v57, v13, v57 quad_perm:[1,1,1,1] row_mask:0xf bank_mask:0xf
  v_add_f32_dpp v57, v14, v57 quad_perm:[2,2,2,2] row_mask:0xf bank_mask:0xf
  v_add_f32_dpp v57, v15, v57 quad_perm:[3,3,3,3] row_mask:0xf bank_mask:0xf
  v_cvt_pk_bf16_f32 v57, v57, v57
  v_and_b32 v57, 0xffff0000, v57
  v_mul_f32 v57, 0x3d93cd3a, v57
  v_cvt_pk_bf16_f32 v57, v57, v57
  v_and_b32 v57, 0xffff0000, v57
  v_max_f32 v79, v79, v57
  v_mfma_f32_16x16x32_bf16 v[12:15], v[84:87], v[28:31], 0
  v_mfma_f32_16x16x32_bf16 v[12:15], v[88:91], v[32:35], v[12:15]
  s_waitcnt vmcnt(4)
  buffer_load_dwordx4 v[180:183], v1, s[36:39], s52 offen offset:0 nt
  v_mfma_f32_16x16x32_bf16 v[12:15], v[92:95], v[36:39], v[12:15]
  v_mfma_f32_16x16x32_bf16 v[12:15], v[96:99], v[40:43], v[12:15]
  s_waitcnt vmcnt(4)
  buffer_load_dwordx4 v[184:187], v1, s[36:39], s52 offen offset:128 nt
  v_mfma_f32_16x16x32_bf16 v[12:15], v[100:103], v[44:47], v[12:15]
  v_mfma_f32_16x16x32_bf16 v[12:15], v[104:107], v[48:51], v[12:15]
  s_waitcnt vmcnt(4)
  buffer_load_dwordx4 v[188:191], v1, s[36:39], s52 offen offset:256 nt
  s_nop 1
  v_mov_b32_dpp v58, v8 quad_perm:[0,0,0,0] row_mask:0xf bank_mask:0xf
  v_add_f32_dpp v58, v9, v58 quad_perm:[1,1,1,1] row_mask:0xf bank_mask:0xf
  v_add_f32_dpp v58, v10, v58 quad_perm:[2,2,2,2] row_mask:0xf bank_mask:0xf
  v_add_f32_dpp v58, v11, v58 quad_perm:[3,3,3,3] row_mask:0xf bank_mask:0xf
  v_cvt_pk_bf16_f32 v58, v58, v58
  v_and_b32 v58, 0xffff0000, v58
  v_mul_f32 v58, 0x3d93cd3a, v58
  v_cvt_pk_bf16_f32 v58, v58, v58
  v_and_b32 v58, 0xffff0000, v58
  v_max_f32 v79, v79, v58
  v_mfma_f32_16x16x32_bf16 v[8:11], v[108:111], v[28:31], 0
  v_mfma_f32_16x16x32_bf16 v[8:11], v[112:115], v[32:35], v[8:11]
  s_waitcnt vmcnt(4)
  buffer_load_dwordx4 v[192:195], v1, s[36:39], s52 offen offset:3072 nt
  v_mfma_f32_16x16x32_bf16 v[8:11], v[116:119], v[36:39], v[8:11]
  v_mfma_f32_16x16x32_bf16 v[8:11], v[120:123], v[40:43], v[8:11]
  s_waitcnt vmcnt(4)
  buffer_load_dwordx4 v[196:199], v1, s[36:39], s52 offen offset:3200 nt
  v_mfma_f32_16x16x32_bf16 v[8:11], v[124:127], v[44:47], v[8:11]
  v_mfma_f32_16x16x32_bf16 v[8:11], v[128:131], v[48:51], v[8:11]
  s_waitcnt vmcnt(4)
  buffer_load_dwordx4 v[200:203], v1, s[36:39], s52 offen offset:3328 nt
  s_add_u32 s52, s52, 6144
  s_nop 1
  v_mov_b32_dpp v59, v12 quad_perm:[0,0,0,0] row_mask:0xf bank_mask:0xf
  v_add_f32_dpp v59, v13, v59 quad_perm:[1,1,1,1] row_mask:0xf bank_mask:0xf
  v_add_f32_dpp v59, v14, v59 quad_perm:[2,2,2,2] row_mask:0xf bank_mask:0xf
  v_add_f32_dpp v59, v15, v59 quad_perm:[3,3,3,3] row_mask:0xf bank_mask:0xf
  v_cvt_pk_bf16_f32 v59, v59, v59
  v_and_b32 v59, 0xffff0000, v59
  v_mul_f32 v59, 0x3d93cd3a, v59
  v_cvt_pk_bf16_f32 v59, v59, v59
  v_and_b32 v59, 0xffff0000, v59
  v_max_f32 v79, v79, v59
  v_mfma_f32_16x16x32_bf16 v[12:15], v[132:135], v[28:31], 0
  v_mfma_f32_16x16x32_bf16 v[12:15], v[136:139], v[32:35], v[12:15]
  s_waitcnt vmcnt(4)
  buffer_load_dwordx4 v[204:207], v1, s[36:39], s52 offen offset:0 nt
  v_mfma_f32_16x16x32_bf16 v[12:15], v[140:143], v[36:39], v[12:15]
  v_mfma_f32_16x16x32_bf16 v[12:15], v[144:147], v[40:43], v[12:15]
  s_waitcnt vmcnt(4)
  buffer_load_dwordx4 v[208:211], v1, s[36:39], s52 offen offset:128 nt
  v_mfma_f32_16x16x32_bf16 v[12:15], v[148:151], v[44:47], v[12:15]
  v_mfma_f32_16x16x32_bf16 v[12:15], v[152:155], v[48:51], v[12:15]
  s_waitcnt vmcnt(4)
  buffer_load_dwordx4 v[212:215], v1, s[36:39], s52 offen offset:256 nt
  s_nop 1
  v_mov_b32_dpp v60, v8 quad_perm:[0,0,0,0] row_mask:0xf bank_mask:0xf
  v_add_f32_dpp v60, v9, v60 quad_perm:[1,1,1,1] row_mask:0xf bank_mask:0xf
  v_add_f32_dpp v60, v10, v60 quad_perm:[2,2,2,2] row_mask:0xf bank_mask:0xf
  v_add_f32_dpp v60, v11, v60 quad_perm:[3,3,3,3] row_mask:0xf bank_mask:0xf
  v_cvt_pk_bf16_f32 v60, v60, v60
  v_and_b32 v60, 0xffff0000, v60
  v_mul_f32 v60, 0x3d93cd3a, v60
  v_cvt_pk_bf16_f32 v60, v60, v60
  v_and_b32 v60, 0xffff0000, v60
  v_max_f32 v79, v79, v60
  v_mfma_f32_16x16x32_bf16 v[8:11], v[156:159], v[28:31], 0
  v_mfma_f32_16x16x32_bf16 v[8:11], v[160:163], v[32:35], v[8:11]
  s_waitcnt vmcnt(4)
  buffer_load_dwordx4 v[216:219], v1, s[36:39], s52 offen offset:3072 nt
  v_mfma_f32_16x16x32_bf16 v[8:11], v[164:167], v[36:39], v[8:11]
  v_mfma_f32_16x16x32_bf16 v[8:11], v[168:171], v[40:43], v[8:11]
  s_waitcnt vmcnt(4)
  buffer_load_dwordx4 v[220:223], v1, s[36:39], s52 offen offset:3200 nt
  v_mfma_f32_16x16x32_bf16 v[8:11], v[172:175], v[44:47], v[8:11]
  v_mfma_f32_16x16x32_bf16 v[8:11], v[176:179], v[48:51], v[8:11]
  s_waitcnt vmcnt(4)
  buffer_load_dwordx4 v[224:227], v1, s[36:39], s52 offen offset:3328 nt
  s_add_u32 s52, s52, 6144
  s_nop 1
  v_mov_b32_dpp v61, v12 quad_perm:[0,0,0,0] row_mask:0xf bank_mask:0xf
  v_add_f32_dpp v61, v13, v61 quad_perm:[1,1,1,1] row_mask:0xf bank_mask:0xf
  v_add_f32_dpp v61, v14, v61 quad_perm:[2,2,2,2] row_mask:0xf bank_mask:0xf
  v_add_f32_dpp v61, v15, v61 quad_perm:[3,3,3,3] row_mask:0xf bank_mask:0xf
  v_cvt_pk_bf16_f32 v61, v61, v61
  v_and_b32 v61, 0xffff0000, v61
  v_mul_f32 v61, 0x3d93cd3a, v61
  v_cvt_pk_bf16_f32 v61, v61, v61
  v_and_b32 v61, 0xffff0000, v61
  v_max_f32 v79, v79, v61
  v_mfma_f32_16x16x32_bf16 v[12:15], v[180:183], v[28:31], 0
  v_mfma_f32_16x16x32_bf16 v[12:15], v[184:187], v[32:35], v[12:15]
  s_waitcnt vmcnt(4)
  buffer_load_dwordx4 v[228:231], v1, s[36:39], s52 offen offset:0 nt
  v_mfma_f32_16x16x32_bf16 v[12:15], v[188:191], v[36:39], v[12:15]
  s_waitcnt vmcnt(9)
  v_mfma_f32_16x16x32_bf16 v[12:15], v[192:195], v[40:43], v[12:15]
  s_waitcnt vmcnt(4)
  buffer_load_dwordx4 v[232:235], v1, s[36:39], s52 offen offset:128 nt
  s_waitcnt vmcnt(9)
  v_mfma_f32_16x16x32_bf16 v[12:15], v[196:199], v[44:47], v[12:15]
  s_waitcnt vmcnt(4)
  buffer_load_dwordx4 v[236:239], v1, s[36:39], s52 offen offset:256 nt
  s_waitcnt vmcnt(9)
  v_mfma_f32_16x16x32_bf16 v[12:15], v[200:203], v[48:51], v[12:15]
  s_waitcnt vmcnt(4)
  buffer_load_dwordx4 v[240:243], v1, s[36:39], s52 offen offset:3072 nt
  s_nop 1
  v_mov_b32_dpp v62, v8 quad_perm:[0,0,0,0] row_mask:0xf bank_mask:0xf
  v_add_f32_dpp v62, v9, v62 quad_perm:[1,1,1,1] row_mask:0xf bank_mask:0xf
  v_add_f32_dpp v62, v10, v62 quad_perm:[2,2,2,2] row_mask:0xf bank_mask:0xf
  v_add_f32_dpp v62, v11, v62 quad_perm:[3,3,3,3] row_mask:0xf bank_mask:0xf
  v_cvt_pk_bf16_f32 v62, v62, v62
  v_and_b32 v62, 0xffff0000, v62
  v_mul_f32 v62, 0x3d93cd3a, v62
  v_cvt_pk_bf16_f32 v62, v62, v62
  v_and_b32 v62, 0xffff0000, v62
  v_max_f32 v79, v79, v62
  s_waitcnt vmcnt(9)
  v_mfma_f32_16x16x32_bf16 v[8:11], v[204:207], v[28:31], 0
  s_waitcnt vmcnt(4)
  buffer_load_dwordx4 v[244:247], v1, s[36:39], s52 offen offset:3200 nt
  s_waitcnt vmcnt(9)
  v_mfma_f32_16x16x32_bf16 v[8:11], v[208:211], v[32:35], v[8:11]
  s_waitcnt vmcnt(4)
  buffer_load_dwordx4 v[248:251], v1, s[36:39], s52 offen offset:3328 nt
  s_add_u32 s52, s52, 6144
  s_waitcnt vmcnt(9)
  v_mfma_f32_16x16x32_bf16 v[8:11], v[212:215], v[36:39], v[8:11]
  s_waitcnt vmcnt(4)
  buffer_load_dwordx4 v[84:87], v1, s[36:39], s52 offen offset:0 nt
  s_waitcnt vmcnt(9)
  v_mfma_f32_16x16x32_bf16 v[8:11], v[216:219], v[40:43], v[8:11]
  s_waitcnt vmcnt(4)
  buffer_load_dwordx4 v[88:91], v1, s[36:39], s52 offen offset:128 nt
  s_waitcnt vmcnt(9)
  v_mfma_f32_16x16x32_bf16 v[8:11], v[220:223], v[44:47], v[8:11]
  s_waitcnt vmcnt(4)
  buffer_load_dwordx4 v[92:95], v1, s[36:39], s52 offen offset:256 nt
  s_waitcnt vmcnt(9)
  v_mfma_f32_16x16x32_bf16 v[8:11], v[224:227], v[48:51], v[8:11]
  s_waitcnt vmcnt(4)
  buffer_load_dwordx4 v[96:99], v1, s[36:39], s52 offen offset:3072 nt
  s_nop 1
  v_mov_b32_dpp v63, v12 quad_perm:[0,0,0,0] row_mask:0xf bank_mask:0xf
  v_add_f32_dpp v63, v13, v63 quad_perm:[1,1,1,1] row_mask:0xf bank_mask:0xf
  v_add_f32_dpp v63, v14, v63 quad_perm:[2,2,2,2] row_mask:0xf bank_mask:0xf
  v_add_f32_dpp v63, v15, v63 quad_perm:[3,3,3,3] row_mask:0xf bank_mask:0xf
  v_cvt_pk_bf16_f32 v63, v63, v63
  v_and_b32 v63, 0xffff0000, v63
  v_mul_f32 v63, 0x3d93cd3a, v63
  v_cvt_pk_bf16_f32 v63, v63, v63
  v_and_b32 v63, 0xffff0000, v63
  v_max_f32 v79, v79, v63
  s_waitcnt vmcnt(9)
  v_mfma_f32_16x16x32_bf16 v[12:15], v[228:231], v[28:31], 0
  s_waitcnt vmcnt(4)
  buffer_load_dwordx4 v[100:103], v1, s[36:39], s52 offen offset:3200 nt
  s_waitcnt vmcnt(9)
  v_mfma_f32_16x16x32_bf16 v[12:15], v[232:235], v[32:35], v[12:15]
  s_waitcnt vmcnt(4)
  buffer_load_dwordx4 v[104:107], v1, s[36:39], s52 offen offset:3328 nt
  s_add_u32 s52, s52, 6144
  s_waitcnt vmcnt(9)
  v_mfma_f32_16x16x32_bf16 v[12:15], v[236:239], v[36:39], v[12:15]
  s_waitcnt vmcnt(4)
  buffer_load_dwordx4 v[108:111], v1, s[36:39], s52 offen offset:0 nt
  s_waitcnt vmcnt(9)
  v_mfma_f32_16x16x32_bf16 v[12:15], v[240:243], v[40:43], v[12:15]
  s_waitcnt vmcnt(4)
  buffer_load_dwordx4 v[112:115], v1, s[36:39], s52 offen offset:128 nt
  s_waitcnt vmcnt(9)
  v_mfma_f32_16x16x32_bf16 v[12:15], v[244:247], v[44:47], v[12:15]
  s_waitcnt vmcnt(4)
  buffer_load_dwordx4 v[116:119], v1, s[36:39], s52 offen offset:256 nt
  s_waitcnt vmcnt(9)
  v_mfma_f32_16x16x32_bf16 v[12:15], v[248:251], v[48:51], v[12:15]
  s_waitcnt vmcnt(4)
  buffer_load_dwordx4 v[120:123], v1, s[36:39], s52 offen offset:3072 nt
  s_nop 1
  v_mov_b32_dpp v64, v8 quad_perm:[0,0,0,0] row_mask:0xf bank_mask:0xf
  v_add_f32_dpp v64, v9, v64 quad_perm:[1,1,1,1] row_mask:0xf bank_mask:0xf
  v_add_f32_dpp v64, v10, v64 quad_perm:[2,2,2,2] row_mask:0xf bank_mask:0xf
  v_add_f32_dpp v64, v11, v64 quad_perm:[3,3,3,3] row_mask:0xf bank_mask:0xf
  v_cvt_pk_bf16_f32 v64, v64, v64
  v_and_b32 v64, 0xffff0000, v64
  v_mul_f32 v64, 0x3d93cd3a, v64
  v_cvt_pk_bf16_f32 v64, v64, v64
  v_and_b32 v64, 0xffff0000, v64
  v_max_f32 v79, v79, v64
  s_waitcnt vmcnt(9)
  v_mfma_f32_16x16x32_bf16 v[8:11], v[84:87], v[28:31], 0
  s_waitcnt vmcnt(4)
  buffer_load_dwordx4 v[124:127], v1, s[36:39], s52 offen offset:3200 nt
  s_waitcnt vmcnt(9)
  v_mfma_f32_16x16x32_bf16 v[8:11], v[88:91], v[32:35], v[8:11]
  s_waitcnt vmcnt(4)
  buffer_load_dwordx4 v[128:131], v1, s[36:39], s52 offen offset:3328 nt
  s_waitcnt vmcnt(9)
  v_mfma_f32_16x16x32_bf16 v[8:11], v[92:95], v[36:39], v[8:11]
  s_waitcnt vmcnt(4)
  buffer_load_dwordx4 v[132:135], v2, s[40:43], s53 offen offset:0 nt
  s_waitcnt vmcnt(9)
  v_mfma_f32_16x16x32_bf16 v[8:11], v[96:99], v[40:43], v[8:11]
  s_waitcnt vmcnt(4)
  buffer_load_dwordx4 v[136:139], v2, s[40:43], s53 offen offset:128 nt
  s_waitcnt vmcnt(9)
  v_mfma_f32_16x16x32_bf16 v[8:11], v[100:103], v[44:47], v[8:11]
  s_waitcnt vmcnt(4)
  buffer_load_dwordx4 v[140:143], v2, s[40:43], s53 offen offset:256 nt
  s_waitcnt vmcnt(9)
  v_mfma_f32_16x16x32_bf16 v[8:11], v[104:107], v[48:51], v[8:11]
  s_waitcnt vmcnt(4)
  buffer_load_dwordx4 v[144:147], v2, s[40:43], s53 offen offset:1536 nt
  s_nop 1
  v_mov_b32_dpp v65, v12 quad_perm:[0,0,0,0] row_mask:0xf bank_mask:0xf
  v_add_f32_dpp v65, v13, v65 quad_perm:[1,1,1,1] row_mask:0xf bank_mask:0xf
  v_add_f32_dpp v65, v14, v65 quad_perm:[2,2,2,2] row_mask:0xf bank_mask:0xf
  v_add_f32_dpp v65, v15, v65 quad_perm:[3,3,3,3] row_mask:0xf bank_mask:0xf
  v_cvt_pk_bf16_f32 v65, v65, v65
  v_and_b32 v65, 0xffff0000, v65
  v_mul_f32 v65, 0x3d93cd3a, v65
  v_cvt_pk_bf16_f32 v65, v65, v65
  v_and_b32 v65, 0xffff0000, v65
  v_max_f32 v79, v79, v65
  s_waitcnt vmcnt(9)
  v_mfma_f32_16x16x32_bf16 v[12:15], v[108:111], v[28:31], 0
  s_waitcnt vmcnt(4)
  buffer_load_dwordx4 v[148:151], v2, s[40:43], s53 offen offset:1664 nt
  s_waitcnt vmcnt(9)
  v_mfma_f32_16x16x32_bf16 v[12:15], v[112:115], v[32:35], v[12:15]
  s_waitcnt vmcnt(4)
  buffer_load_dwordx4 v[152:155], v2, s[40:43], s53 offen offset:1792 nt
  s_add_u32 s53, s53, 6144
  s_waitcnt vmcnt(9)
  v_mfma_f32_16x16x32_bf16 v[12:15], v[116:119], v[36:39], v[12:15]
  s_waitcnt vmcnt(4)
  buffer_load_dwordx4 v[156:159], v2, s[40:43], s53 offen offset:0 nt
  s_waitcnt vmcnt(9)
  v_mfma_f32_16x16x32_bf16 v[12:15], v[120:123], v[40:43], v[12:15]
  s_waitcnt vmcnt(4)
  buffer_load_dwordx4 v[160:163], v2, s[40:43], s53 offen offset:128 nt
  s_waitcnt vmcnt(9)
  v_mfma_f32_16x16x32_bf16 v[12:15], v[124:127], v[44:47], v[12:15]
  s_waitcnt vmcnt(4)
  buffer_load_dwordx4 v[164:167], v2, s[40:43], s53 offen offset:256 nt
  s_waitcnt vmcnt(9)
  v_mfma_f32_16x16x32_bf16 v[12:15], v[128:131], v[48:51], v[12:15]
  s_waitcnt vmcnt(4)
  buffer_load_dwordx4 v[168:171], v2, s[40:43], s53 offen offset:1536 nt
  s_nop 1
  v_mov_b32_dpp v66, v8 quad_perm:[0,0,0,0] row_mask:0xf bank_mask:0xf
  v_add_f32_dpp v66, v9, v66 quad_perm:[1,1,1,1] row_mask:0xf bank_mask:0xf
  v_add_f32_dpp v66, v10, v66 quad_perm:[2,2,2,2] row_mask:0xf bank_mask:0xf
  v_add_f32_dpp v66, v11, v66 quad_perm:[3,3,3,3] row_mask:0xf bank_mask:0xf
  v_cvt_pk_bf16_f32 v66, v66, v66
  v_and_b32 v66, 0xffff0000, v66
  v_mul_f32 v66, 0x3d93cd3a, v66
  v_cvt_pk_bf16_f32 v66, v66, v66
  v_and_b32 v66, 0xffff0000, v66
  v_max_f32 v79, v79, v66
  s_nop 7
  v_mov_b32_dpp v67, v12 quad_perm:[0,0,0,0] row_mask:0xf bank_mask:0xf
  v_add_f32_dpp v67, v13, v67 quad_perm:[1,1,1,1] row_mask:0xf bank_mask:0xf
  v_add_f32_dpp v67, v14, v67 quad_perm:[2,2,2,2] row_mask:0xf bank_mask:0xf
  v_add_f32_dpp v67, v15, v67 quad_perm:[3,3,3,3] row_mask:0xf bank_mask:0xf
  v_cvt_pk_bf16_f32 v67, v67, v67
  v_and_b32 v67, 0xffff0000, v67
  v_mul_f32 v67, 0x3d93cd3a, v67
  v_cvt_pk_bf16_f32 v67, v67, v67
  v_and_b32 v67, 0xffff0000, v67
  v_max_f32 v79, v79, v67
  s_nop 1
  v_max_f32_dpp v79, v79, v79 row_half_mirror row_mask:0xf bank_mask:0xf
  s_nop 1
  v_max_f32_dpp v79, v79, v79 row_mirror row_mask:0xf bank_mask:0xf
  v_mov_b32 v80, v79
  s_nop 1
  v_permlane16_swap_b32 v80, v79
  v_max_f32 v79, v79, v80
  v_mov_b32 v80, v79
  s_nop 1
  v_permlane32_swap_b32 v80, v79
  v_max_f32 v79, v79, v80
  v_sub_f32 v52, v52, v79
  v_mul_f32 v52, 0x3fb8aa3b, v52
  v_exp_f32 v52, v52
  s_nop 0
  v_mov_b32 v80, v52
  v_cvt_pk_bf16_f32 v52, v52, v52
  s_nop 0
  v_and_b32 v68, v52, v4
  v_and_b32 v69, v52, v5
  v_and_b32_dpp v70, v52, v6 row_half_mirror row_mask:0xf bank_mask:0xf
  v_and_b32_dpp v71, v52, v7 row_half_mirror row_mask:0xf bank_mask:0xf
  v_and_b32_dpp v72, v52, v4 row_half_mirror row_mask:0xf bank_mask:0xf
  v_and_b32_dpp v73, v52, v5 row_half_mirror row_mask:0xf bank_mask:0xf
  v_and_b32 v74, v52, v6
  v_and_b32 v75, v52, v7
  s_waitcnt vmcnt(9)
  v_mfma_f32_16x16x32_bf16 v[16:19], v[68:71], v[132:135], 0
  v_sub_f32 v53, v53, v79
  v_mul_f32 v53, 0x3fb8aa3b, v53
  v_exp_f32 v53, v53
  s_nop 0
  v_add_f32 v80, v80, v53
  v_cvt_pk_bf16_f32 v53, v53, v53
  s_waitcnt vmcnt(8)
  v_mfma_f32_16x16x32_bf16 v[20:23], v[68:71], v[136:139], 0
  v_sub_f32 v54, v54, v79
  v_mul_f32 v54, 0x3fb8aa3b, v54
  v_exp_f32 v54, v54
  s_nop 0
  v_add_f32 v80, v80, v54
  v_cvt_pk_bf16_f32 v54, v54, v54
  s_waitcnt vmcnt(7)
  v_mfma_f32_16x16x32_bf16 v[24:27], v[68:71], v[140:143], 0
  v_sub_f32 v55, v55, v79
  v_mul_f32 v55, 0x3fb8aa3b, v55
  v_exp_f32 v55, v55
  s_nop 0
  v_add_f32 v80, v80, v55
  v_cvt_pk_bf16_f32 v55, v55, v55
  s_waitcnt vmcnt(6)
  v_mfma_f32_16x16x32_bf16 v[16:19], v[72:75], v[144:147], v[16:19]
  v_sub_f32 v56, v56, v79
  v_mul_f32 v56, 0x3fb8aa3b, v56
  v_exp_f32 v56, v56
  s_nop 0
  v_add_f32 v80, v80, v56
  v_cvt_pk_bf16_f32 v56, v56, v56
  s_waitcnt vmcnt(5)
  v_mfma_f32_16x16x32_bf16 v[20:23], v[72:75], v[148:151], v[20:23]
  v_sub_f32 v57, v57, v79
  v_mul_f32 v57, 0x3fb8aa3b, v57
  v_exp_f32 v57, v57
  s_nop 0
  v_add_f32 v80, v80, v57
  v_cvt_pk_bf16_f32 v57, v57, v57
  s_waitcnt vmcnt(4)
  v_mfma_f32_16x16x32_bf16 v[24:27], v[72:75], v[152:155], v[24:27]
  s_waitcnt vmcnt(4)
  buffer_load_dwordx4 v[172:175], v2, s[40:43], s53 offen offset:1664 nt
  v_sub_f32 v58, v58, v79
  v_mul_f32 v58, 0x3fb8aa3b, v58
  v_exp_f32 v58, v58
  s_nop 0
  v_add_f32 v80, v80, v58
  v_cvt_pk_bf16_f32 v58, v58, v58
  v_and_b32 v68, v53, v4
  v_and_b32 v69, v53, v5
  v_and_b32_dpp v70, v53, v6 row_half_mirror row_mask:0xf bank_mask:0xf
  v_and_b32_dpp v71, v53, v7 row_half_mirror row_mask:0xf bank_mask:0xf
  v_and_b32_dpp v72, v53, v4 row_half_mirror row_mask:0xf bank_mask:0xf
  v_and_b32_dpp v73, v53, v5 row_half_mirror row_mask:0xf bank_mask:0xf
  v_and_b32 v74, v53, v6
  v_and_b32 v75, v53, v7
  s_waitcnt vmcnt(4)
  v_mfma_f32_16x16x32_bf16 v[16:19], v[68:71], v[156:159], v[16:19]
  s_waitcnt vmcnt(4)
  buffer_load_dwordx4 v[176:179], v2, s[40:43], s53 offen offset:1792 nt
  s_add_u32 s53, s53, 6144
  v_sub_f32 v59, v59, v79
  v_mul_f32 v59, 0x3fb8aa3b, v59
  v_exp_f32 v59, v59
  s_nop 0
  v_add_f32 v80, v80, v59
  v_cvt_pk_bf16_f32 v59, v59, v59
  s_waitcnt vmcnt(4)
  v_mfma_f32_16x16x32_bf16 v[20:23], v[68:71], v[160:163], v[20:23]
  s_waitcnt vmcnt(4)
  buffer_load_dwordx4 v[180:183], v2, s[40:43], s53 offen offset:0 nt
  v_sub_f32 v60, v60, v79
  v_mul_f32 v60, 0x3fb8aa3b, v60
  v_exp_f32 v60, v60
  s_nop 0
  v_add_f32 v80, v80, v60
  v_cvt_pk_bf16_f32 v60, v60, v60
  s_waitcnt vmcnt(4)
  v_mfma_f32_16x16x32_bf16 v[24:27], v[68:71], v[164:167], v[24:27]
  s_waitcnt vmcnt(4)
  buffer_load_dwordx4 v[184:187], v2, s[40:43], s53 offen offset:128 nt
  v_sub_f32 v61, v61, v79
  v_mul_f32 v61, 0x3fb8aa3b, v61
  v_exp_f32 v61, v61
  s_nop 0
  v_add_f32 v80, v80, v61
  v_cvt_pk_bf16_f32 v61, v61, v61
  s_waitcnt vmcnt(4)
  v_mfma_f32_16x16x32_bf16 v[16:19], v[72:75], v[168:171], v[16:19]
  s_waitcnt vmcnt(4)
  buffer_load_dwordx4 v[188:191], v2, s[40:43], s53 offen offset:256 nt
  v_sub_f32 v62, v62, v79
  v_mul_f32 v62, 0x3fb8aa3b, v62
  v_exp_f32 v62, v62
  s_nop 0
  v_add_f32 v80, v80, v62
  v_cvt_pk_bf16_f32 v62, v62, v62
  s_waitcnt vmcnt(4)
  v_mfma_f32_16x16x32_bf16 v[20:23], v[72:75], v[172:175], v[20:23]
  s_waitcnt vmcnt(4)
  buffer_load_dwordx4 v[192:195], v2, s[40:43], s53 offen offset:1536 nt
  v_sub_f32 v63, v63, v79
  v_mul_f32 v63, 0x3fb8aa3b, v63
  v_exp_f32 v63, v63
  s_nop 0
  v_add_f32 v80, v80, v63
  v_cvt_pk_bf16_f32 v63, v63, v63
  s_waitcnt vmcnt(4)
  v_mfma_f32_16x16x32_bf16 v[24:27], v[72:75], v[176:179], v[24:27]
  s_waitcnt vmcnt(4)
  buffer_load_dwordx4 v[196:199], v2, s[40:43], s53 offen offset:1664 nt
  v_sub_f32 v64, v64, v79
  v_mul_f32 v64, 0x3fb8aa3b, v64
  v_exp_f32 v64, v64
  s_nop 0
  v_add_f32 v80, v80, v64
  v_cvt_pk_bf16_f32 v64, v64, v64
  v_and_b32 v68, v54, v4
  v_and_b32 v69, v54, v5
  v_and_b32_dpp v70, v54, v6 row_half_mirror row_mask:0xf bank_mask:0xf
  v_and_b32_dpp v71, v54, v7 row_half_mirror row_mask:0xf bank_mask:0xf
  v_and_b32_dpp v72, v54, v4 row_half_mirror row_mask:0xf bank_mask:0xf
  v_and_b32_dpp v73, v54, v5 row_half_mirror row_mask:0xf bank_mask:0xf
  v_and_b32 v74, v54, v6
  v_and_b32 v75, v54, v7
  s_waitcnt vmcnt(4)
  v_mfma_f32_16x16x32_bf16 v[16:19], v[68:71], v[180:183], v[16:19]
  s_waitcnt vmcnt(4)
  buffer_load_dwordx4 v[200:203], v2, s[40:43], s53 offen offset:1792 nt
  s_add_u32 s53, s53, 6144
  v_sub_f32 v65, v65, v79
  v_mul_f32 v65, 0x3fb8aa3b, v65
  v_exp_f32 v65, v65
  s_nop 0
  v_add_f32 v80, v80, v65
  v_cvt_pk_bf16_f32 v65, v65, v65
  s_waitcnt vmcnt(4)
  v_mfma_f32_16x16x32_bf16 v[20:23], v[68:71], v[184:187], v[20:23]
  s_waitcnt vmcnt(4)
  buffer_load_dwordx4 v[204:207], v2, s[40:43], s53 offen offset:0 nt
  v_sub_f32 v66, v66, v79
  v_mul_f32 v66, 0x3fb8aa3b, v66
  v_exp_f32 v66, v66
  s_nop 0
  v_add_f32 v80, v80, v66
  v_cvt_pk_bf16_f32 v66, v66, v66
  s_waitcnt vmcnt(4)
  v_mfma_f32_16x16x32_bf16 v[24:27], v[68:71], v[188:191], v[24:27]
  s_waitcnt vmcnt(4)
  buffer_load_dwordx4 v[208:211], v2, s[40:43], s53 offen offset:128 nt
  v_sub_f32 v67, v67, v79
  v_mul_f32 v67, 0x3fb8aa3b, v67
  v_exp_f32 v67, v67
  s_nop 0
  v_add_f32 v80, v80, v67
  v_cvt_pk_bf16_f32 v67, v67, v67
  s_waitcnt vmcnt(4)
  v_mfma_f32_16x16x32_bf16 v[16:19], v[72:75], v[192:195], v[16:19]
  s_waitcnt vmcnt(4)
  buffer_load_dwordx4 v[212:215], v2, s[40:43], s53 offen offset:256 nt
  v_add_f32_dpp v80, v80, v80 row_half_mirror row_mask:0xf bank_mask:0xf
  s_nop 1
  v_add_f32_dpp v80, v80, v80 row_mirror row_mask:0xf bank_mask:0xf
  v_mov_b32 v81, v80
  s_nop 1
  v_permlane16_swap_b32 v81, v80
  v_add_f32 v80, v80, v81
  v_mov_b32 v81, v80
  s_nop 1
  v_permlane32_swap_b32 v81, v80
  v_add_f32 v80, v80, v81
  v_mov_b32 v8, v79
  v_mov_b32 v9, v80
  v_mov_b32 v10, 1
  v_mov_b32 v11, 1
  s_lshl_b32 s48, s55, 4
  v_mov_b32 v81, s48
  ds_write_b128 v81, v[8:11] offset:2432
  s_waitcnt vmcnt(4)
  v_mfma_f32_16x16x32_bf16 v[20:23], v[72:75], v[196:199], v[20:23]
  s_waitcnt vmcnt(4)
  buffer_load_dwordx4 v[216:219], v2, s[40:43], s53 offen offset:1536 nt
  s_waitcnt vmcnt(4)
  v_mfma_f32_16x16x32_bf16 v[24:27], v[72:75], v[200:203], v[24:27]
  s_waitcnt vmcnt(4)
  buffer_load_dwordx4 v[220:223], v2, s[40:43], s53 offen offset:1664 nt
  v_and_b32 v68, v55, v4
  v_and_b32 v69, v55, v5
  v_and_b32_dpp v70, v55, v6 row_half_mirror row_mask:0xf bank_mask:0xf
  v_and_b32_dpp v71, v55, v7 row_half_mirror row_mask:0xf bank_mask:0xf
  v_and_b32_dpp v72, v55, v4 row_half_mirror row_mask:0xf bank_mask:0xf
  v_and_b32_dpp v73, v55, v5 row_half_mirror row_mask:0xf bank_mask:0xf
  v_and_b32 v74, v55, v6
  v_and_b32 v75, v55, v7
  s_waitcnt vmcnt(4)
  v_mfma_f32_16x16x32_bf16 v[16:19], v[68:71], v[204:207], v[16:19]
  s_waitcnt vmcnt(4)
  buffer_load_dwordx4 v[224:227], v2, s[40:43], s53 offen offset:1792 nt
  s_add_u32 s53, s53, 6144
  s_waitcnt vmcnt(4)
  v_mfma_f32_16x16x32_bf16 v[20:23], v[68:71], v[208:211], v[20:23]
  s_waitcnt vmcnt(4)
  buffer_load_dwordx4 v[228:231], v2, s[40:43], s53 offen offset:0 nt
  s_waitcnt vmcnt(4)
  v_mfma_f32_16x16x32_bf16 v[24:27], v[68:71], v[212:215], v[24:27]
  s_waitcnt vmcnt(4)
  buffer_load_dwordx4 v[232:235], v2, s[40:43], s53 offen offset:128 nt
  s_waitcnt vmcnt(4)
  v_mfma_f32_16x16x32_bf16 v[16:19], v[72:75], v[216:219], v[16:19]
  s_waitcnt vmcnt(4)
  buffer_load_dwordx4 v[236:239], v2, s[40:43], s53 offen offset:256 nt
  s_waitcnt vmcnt(4)
  v_mfma_f32_16x16x32_bf16 v[20:23], v[72:75], v[220:223], v[20:23]
  s_waitcnt vmcnt(4)
  buffer_load_dwordx4 v[240:243], v2, s[40:43], s53 offen offset:1536 nt
  s_waitcnt vmcnt(4)
  v_mfma_f32_16x16x32_bf16 v[24:27], v[72:75], v[224:227], v[24:27]
  s_waitcnt vmcnt(4)
  buffer_load_dwordx4 v[244:247], v2, s[40:43], s53 offen offset:1664 nt
  v_and_b32 v68, v56, v4
  v_and_b32 v69, v56, v5
  v_and_b32_dpp v70, v56, v6 row_half_mirror row_mask:0xf bank_mask:0xf
  v_and_b32_dpp v71, v56, v7 row_half_mirror row_mask:0xf bank_mask:0xf
  v_and_b32_dpp v72, v56, v4 row_half_mirror row_mask:0xf bank_mask:0xf
  v_and_b32_dpp v73, v56, v5 row_half_mirror row_mask:0xf bank_mask:0xf
  v_and_b32 v74, v56, v6
  v_and_b32 v75, v56, v7
  s_waitcnt vmcnt(4)
  v_mfma_f32_16x16x32_bf16 v[16:19], v[68:71], v[228:231], v[16:19]
  s_waitcnt vmcnt(4)
  buffer_load_dwordx4 v[248:251], v2, s[40:43], s53 offen offset:1792 nt
  s_add_u32 s53, s53, 6144
  s_waitcnt vmcnt(4)
  v_mfma_f32_16x16x32_bf16 v[20:23], v[68:71], v[232:235], v[20:23]
  s_waitcnt vmcnt(4)
  buffer_load_dwordx4 v[84:87], v2, s[40:43], s53 offen offset:0 nt
  s_waitcnt vmcnt(4)
  v_mfma_f32_16x16x32_bf16 v[24:27], v[68:71], v[236:239], v[24:27]
  s_waitcnt vmcnt(4)
  buffer_load_dwordx4 v[88:91], v2, s[40:43], s53 offen offset:128 nt
  s_waitcnt vmcnt(4)
  v_mfma_f32_16x16x32_bf16 v[16:19], v[72:75], v[240:243], v[16:19]
  s_waitcnt vmcnt(4)
  buffer_load_dwordx4 v[92:95], v2, s[40:43], s53 offen offset:256 nt
  s_waitcnt vmcnt(4)
  v_mfma_f32_16x16x32_bf16 v[20:23], v[72:75], v[244:247], v[20:23]
  s_waitcnt vmcnt(4)
  buffer_load_dwordx4 v[96:99], v2, s[40:43], s53 offen offset:1536 nt
  s_waitcnt vmcnt(4)
  v_mfma_f32_16x16x32_bf16 v[24:27], v[72:75], v[248:251], v[24:27]
  s_waitcnt vmcnt(4)
  buffer_load_dwordx4 v[100:103], v2, s[40:43], s53 offen offset:1664 nt
  v_and_b32 v68, v57, v4
  v_and_b32 v69, v57, v5
  v_and_b32_dpp v70, v57, v6 row_half_mirror row_mask:0xf bank_mask:0xf
  v_and_b32_dpp v71, v57, v7 row_half_mirror row_mask:0xf bank_mask:0xf
  v_and_b32_dpp v72, v57, v4 row_half_mirror row_mask:0xf bank_mask:0xf
  v_and_b32_dpp v73, v57, v5 row_half_mirror row_mask:0xf bank_mask:0xf
  v_and_b32 v74, v57, v6
  v_and_b32 v75, v57, v7
  s_waitcnt vmcnt(4)
  v_mfma_f32_16x16x32_bf16 v[16:19], v[68:71], v[84:87], v[16:19]
  s_waitcnt vmcnt(4)
  buffer_load_dwordx4 v[104:107], v2, s[40:43], s53 offen offset:1792 nt
  s_add_u32 s53, s53, 6144
  s_waitcnt vmcnt(4)
  v_mfma_f32_16x16x32_bf16 v[20:23], v[68:71], v[88:91], v[20:23]
  s_waitcnt vmcnt(4)
  buffer_load_dwordx4 v[108:111], v2, s[40:43], s53 offen offset:0 nt
  s_waitcnt vmcnt(4)
  v_mfma_f32_16x16x32_bf16 v[24:27], v[68:71], v[92:95], v[24:27]
  s_waitcnt vmcnt(4)
  buffer_load_dwordx4 v[112:115], v2, s[40:43], s53 offen offset:128 nt
  s_waitcnt vmcnt(4)
  v_mfma_f32_16x16x32_bf16 v[16:19], v[72:75], v[96:99], v[16:19]
  s_waitcnt vmcnt(4)
  buffer_load_dwordx4 v[116:119], v2, s[40:43], s53 offen offset:256 nt
  s_waitcnt vmcnt(4)
  v_mfma_f32_16x16x32_bf16 v[20:23], v[72:75], v[100:103], v[20:23]
  s_waitcnt vmcnt(4)
  buffer_load_dwordx4 v[120:123], v2, s[40:43], s53 offen offset:1536 nt
  s_waitcnt vmcnt(4)
  v_mfma_f32_16x16x32_bf16 v[24:27], v[72:75], v[104:107], v[24:27]
  s_waitcnt vmcnt(4)
  buffer_load_dwordx4 v[124:127], v2, s[40:43], s53 offen offset:1664 nt
  v_and_b32 v68, v58, v4
  v_and_b32 v69, v58, v5
  v_and_b32_dpp v70, v58, v6 row_half_mirror row_mask:0xf bank_mask:0xf
  v_and_b32_dpp v71, v58, v7 row_half_mirror row_mask:0xf bank_mask:0xf
  v_and_b32_dpp v72, v58, v4 row_half_mirror row_mask:0xf bank_mask:0xf
  v_and_b32_dpp v73, v58, v5 row_half_mirror row_mask:0xf bank_mask:0xf
  v_and_b32 v74, v58, v6
  v_and_b32 v75, v58, v7
  s_waitcnt vmcnt(4)
  v_mfma_f32_16x16x32_bf16 v[16:19], v[68:71], v[108:111], v[16:19]
  s_waitcnt vmcnt(4)
  buffer_load_dwordx4 v[128:131], v2, s[40:43], s53 offen offset:1792 nt
  s_add_u32 s53, s53, 6144
  s_waitcnt vmcnt(4)
  v_mfma_f32_16x16x32_bf16 v[20:23], v[68:71], v[112:115], v[20:23]
  s_waitcnt vmcnt(4)
  buffer_load_dwordx4 v[132:135], v2, s[40:43], s53 offen offset:0 nt
  s_waitcnt vmcnt(4)
  v_mfma_f32_16x16x32_bf16 v[24:27], v[68:71], v[116:119], v[24:27]
  s_waitcnt vmcnt(4)
  buffer_load_dwordx4 v[136:139], v2, s[40:43], s53 offen offset:128 nt
  s_waitcnt vmcnt(4)
  v_mfma_f32_16x16x32_bf16 v[16:19], v[72:75], v[120:123], v[16:19]
  s_waitcnt vmcnt(4)
  buffer_load_dwordx4 v[140:143], v2, s[40:43], s53 offen offset:256 nt
  s_waitcnt vmcnt(4)
  v_mfma_f32_16x16x32_bf16 v[20:23], v[72:75], v[124:127], v[20:23]
  s_waitcnt vmcnt(4)
  buffer_load_dwordx4 v[144:147], v2, s[40:43], s53 offen offset:1536 nt
  s_waitcnt vmcnt(4)
  v_mfma_f32_16x16x32_bf16 v[24:27], v[72:75], v[128:131], v[24:27]
  s_waitcnt vmcnt(4)
  buffer_load_dwordx4 v[148:151], v2, s[40:43], s53 offen offset:1664 nt
  v_and_b32 v68, v59, v4
  v_and_b32 v69, v59, v5
  v_and_b32_dpp v70, v59, v6 row_half_mirror row_mask:0xf bank_mask:0xf
  v_and_b32_dpp v71, v59, v7 row_half_mirror row_mask:0xf bank_mask:0xf
  v_and_b32_dpp v72, v59, v4 row_half_mirror row_mask:0xf bank_mask:0xf
  v_and_b32_dpp v73, v59, v5 row_half_mirror row_mask:0xf bank_mask:0xf
  v_and_b32 v74, v59, v6
  v_and_b32 v75, v59, v7
  s_waitcnt vmcnt(4)
  v_mfma_f32_16x16x32_bf16 v[16:19], v[68:71], v[132:135], v[16:19]
  s_waitcnt vmcnt(4)
  buffer_load_dwordx4 v[152:155], v2, s[40:43], s53 offen offset:1792 nt
  s_add_u32 s53, s53, 6144
  s_waitcnt vmcnt(4)
  v_mfma_f32_16x16x32_bf16 v[20:23], v[68:71], v[136:139], v[20:23]
  s_waitcnt vmcnt(4)
  buffer_load_dwordx4 v[156:159], v2, s[40:43], s53 offen offset:0 nt
  s_waitcnt vmcnt(4)
  v_mfma_f32_16x16x32_bf16 v[24:27], v[68:71], v[140:143], v[24:27]
  s_waitcnt vmcnt(4)
  buffer_load_dwordx4 v[160:163], v2, s[40:43], s53 offen offset:128 nt
  s_waitcnt vmcnt(4)
  v_mfma_f32_16x16x32_bf16 v[16:19], v[72:75], v[144:147], v[16:19]
  s_waitcnt vmcnt(4)
  buffer_load_dwordx4 v[164:167], v2, s[40:43], s53 offen offset:256 nt
  s_waitcnt vmcnt(4)
  v_mfma_f32_16x16x32_bf16 v[20:23], v[72:75], v[148:151], v[20:23]
  s_waitcnt vmcnt(4)
  buffer_load_dwordx4 v[168:171], v2, s[40:43], s53 offen offset:1536 nt
  s_waitcnt vmcnt(4)
  v_mfma_f32_16x16x32_bf16 v[24:27], v[72:75], v[152:155], v[24:27]
  s_waitcnt vmcnt(4)
  buffer_load_dwordx4 v[172:175], v2, s[40:43], s53 offen offset:1664 nt
  v_and_b32 v68, v60, v4
  v_and_b32 v69, v60, v5
  v_and_b32_dpp v70, v60, v6 row_half_mirror row_mask:0xf bank_mask:0xf
  v_and_b32_dpp v71, v60, v7 row_half_mirror row_mask:0xf bank_mask:0xf
  v_and_b32_dpp v72, v60, v4 row_half_mirror row_mask:0xf bank_mask:0xf
  v_and_b32_dpp v73, v60, v5 row_half_mirror row_mask:0xf bank_mask:0xf
  v_and_b32 v74, v60, v6
  v_and_b32 v75, v60, v7
  s_waitcnt vmcnt(4)
  v_mfma_f32_16x16x32_bf16 v[16:19], v[68:71], v[156:159], v[16:19]
  s_waitcnt vmcnt(4)
  buffer_load_dwordx4 v[176:179], v2, s[40:43], s53 offen offset:1792 nt
  s_add_u32 s53, s53, 6144
  s_waitcnt vmcnt(4)
  v_mfma_f32_16x16x32_bf16 v[20:23], v[68:71], v[160:163], v[20:23]
  s_waitcnt vmcnt(4)
  buffer_load_dwordx4 v[180:183], v2, s[40:43], s53 offen offset:0 nt
  s_waitcnt vmcnt(4)
  v_mfma_f32_16x16x32_bf16 v[24:27], v[68:71], v[164:167], v[24:27]
  s_waitcnt vmcnt(4)
  buffer_load_dwordx4 v[184:187], v2, s[40:43], s53 offen offset:128 nt
  s_waitcnt vmcnt(4)
  v_mfma_f32_16x16x32_bf16 v[16:19], v[72:75], v[168:171], v[16:19]
  s_waitcnt vmcnt(4)
  buffer_load_dwordx4 v[188:191], v2, s[40:43], s53 offen offset:256 nt
  s_waitcnt vmcnt(4)
  v_mfma_f32_16x16x32_bf16 v[20:23], v[72:75], v[172:175], v[20:23]
  s_waitcnt vmcnt(4)
  buffer_load_dwordx4 v[192:195], v2, s[40:43], s53 offen offset:1536 nt
  s_waitcnt vmcnt(4)
  v_mfma_f32_16x16x32_bf16 v[24:27], v[72:75], v[176:179], v[24:27]
  s_waitcnt vmcnt(4)
  buffer_load_dwordx4 v[196:199], v2, s[40:43], s53 offen offset:1664 nt
  v_and_b32 v68, v61, v4
  v_and_b32 v69, v61, v5
  v_and_b32_dpp v70, v61, v6 row_half_mirror row_mask:0xf bank_mask:0xf
  v_and_b32_dpp v71, v61, v7 row_half_mirror row_mask:0xf bank_mask:0xf
  v_and_b32_dpp v72, v61, v4 row_half_mirror row_mask:0xf bank_mask:0xf
  v_and_b32_dpp v73, v61, v5 row_half_mirror row_mask:0xf bank_mask:0xf
  v_and_b32 v74, v61, v6
  v_and_b32 v75, v61, v7
  s_waitcnt vmcnt(4)
  v_mfma_f32_16x16x32_bf16 v[16:19], v[68:71], v[180:183], v[16:19]
  s_waitcnt vmcnt(4)
  buffer_load_dwordx4 v[200:203], v2, s[40:43], s53 offen offset:1792 nt
  s_add_u32 s53, s53, 6144
  s_waitcnt vmcnt(4)
  v_mfma_f32_16x16x32_bf16 v[20:23], v[68:71], v[184:187], v[20:23]
  s_waitcnt vmcnt(4)
  buffer_load_dwordx4 v[204:207], v2, s[40:43], s53 offen offset:0 nt
  s_waitcnt vmcnt(4)
  v_mfma_f32_16x16x32_bf16 v[24:27], v[68:71], v[188:191], v[24:27]
  s_waitcnt vmcnt(4)
  buffer_load_dwordx4 v[208:211], v2, s[40:43], s53 offen offset:128 nt
  s_waitcnt vmcnt(4)
  v_mfma_f32_16x16x32_bf16 v[16:19], v[72:75], v[192:195], v[16:19]
  s_waitcnt vmcnt(4)
  buffer_load_dwordx4 v[212:215], v2, s[40:43], s53 offen offset:256 nt
  s_waitcnt vmcnt(4)
  v_mfma_f32_16x16x32_bf16 v[20:23], v[72:75], v[196:199], v[20:23]
  s_waitcnt vmcnt(4)
  buffer_load_dwordx4 v[216:219], v2, s[40:43], s53 offen offset:1536 nt
  s_waitcnt vmcnt(4)
  v_mfma_f32_16x16x32_bf16 v[24:27], v[72:75], v[200:203], v[24:27]
  s_waitcnt vmcnt(4)
  buffer_load_dwordx4 v[220:223], v2, s[40:43], s53 offen offset:1664 nt
  v_and_b32 v68, v62, v4
  v_and_b32 v69, v62, v5
  v_and_b32_dpp v70, v62, v6 row_half_mirror row_mask:0xf bank_mask:0xf
  v_and_b32_dpp v71, v62, v7 row_half_mirror row_mask:0xf bank_mask:0xf
  v_and_b32_dpp v72, v62, v4 row_half_mirror row_mask:0xf bank_mask:0xf
  v_and_b32_dpp v73, v62, v5 row_half_mirror row_mask:0xf bank_mask:0xf
  v_and_b32 v74, v62, v6
  v_and_b32 v75, v62, v7
  s_waitcnt vmcnt(4)
  v_mfma_f32_16x16x32_bf16 v[16:19], v[68:71], v[204:207], v[16:19]
  s_waitcnt vmcnt(4)
  buffer_load_dwordx4 v[224:227], v2, s[40:43], s53 offen offset:1792 nt
  s_add_u32 s53, s53, 6144
  s_waitcnt vmcnt(4)
  v_mfma_f32_16x16x32_bf16 v[20:23], v[68:71], v[208:211], v[20:23]
  s_waitcnt vmcnt(4)
  buffer_load_dwordx4 v[228:231], v2, s[40:43], s53 offen offset:0 nt
  s_waitcnt vmcnt(4)
  v_mfma_f32_16x16x32_bf16 v[24:27], v[68:71], v[212:215], v[24:27]
  s_waitcnt vmcnt(4)
  buffer_load_dwordx4 v[232:235], v2, s[40:43], s53 offen offset:128 nt
  s_waitcnt vmcnt(4)
  v_mfma_f32_16x16x32_bf16 v[16:19], v[72:75], v[216:219], v[16:19]
  s_waitcnt vmcnt(4)
  buffer_load_dwordx4 v[236:239], v2, s[40:43], s53 offen offset:256 nt
  s_waitcnt vmcnt(4)
  v_mfma_f32_16x16x32_bf16 v[20:23], v[72:75], v[220:223], v[20:23]
  s_waitcnt vmcnt(4)
  buffer_load_dwordx4 v[240:243], v2, s[40:43], s53 offen offset:1536 nt
  s_waitcnt vmcnt(4)
  v_mfma_f32_16x16x32_bf16 v[24:27], v[72:75], v[224:227], v[24:27]
  s_waitcnt vmcnt(4)
  buffer_load_dwordx4 v[244:247], v2, s[40:43], s53 offen offset:1664 nt
  v_and_b32 v68, v63, v4
  v_and_b32 v69, v63, v5
  v_and_b32_dpp v70, v63, v6 row_half_mirror row_mask:0xf bank_mask:0xf
  v_and_b32_dpp v71, v63, v7 row_half_mirror row_mask:0xf bank_mask:0xf
  v_and_b32_dpp v72, v63, v4 row_half_mirror row_mask:0xf bank_mask:0xf
  v_and_b32_dpp v73, v63, v5 row_half_mirror row_mask:0xf bank_mask:0xf
  v_and_b32 v74, v63, v6
  v_and_b32 v75, v63, v7
  s_waitcnt vmcnt(4)
  v_mfma_f32_16x16x32_bf16 v[16:19], v[68:71], v[228:231], v[16:19]
  s_waitcnt vmcnt(4)
  buffer_load_dwordx4 v[248:251], v2, s[40:43], s53 offen offset:1792 nt
  s_add_u32 s53, s53, 6144
  s_waitcnt vmcnt(4)
  v_mfma_f32_16x16x32_bf16 v[20:23], v[68:71], v[232:235], v[20:23]
  s_waitcnt vmcnt(4)
  buffer_load_dwordx4 v[84:87], v2, s[40:43], s53 offen offset:0 nt
  s_waitcnt vmcnt(4)
  v_mfma_f32_16x16x32_bf16 v[24:27], v[68:71], v[236:239], v[24:27]
  s_waitcnt vmcnt(4)
  buffer_load_dwordx4 v[88:91], v2, s[40:43], s53 offen offset:128 nt
  s_waitcnt vmcnt(4)
  v_mfma_f32_16x16x32_bf16 v[16:19], v[72:75], v[240:243], v[16:19]
  s_waitcnt vmcnt(4)
  buffer_load_dwordx4 v[92:95], v2, s[40:43], s53 offen offset:256 nt
  s_waitcnt vmcnt(4)
  v_mfma_f32_16x16x32_bf16 v[20:23], v[72:75], v[244:247], v[20:23]
  s_waitcnt vmcnt(4)
  buffer_load_dwordx4 v[96:99], v2, s[40:43], s53 offen offset:1536 nt
  s_waitcnt vmcnt(4)
  v_mfma_f32_16x16x32_bf16 v[24:27], v[72:75], v[248:251], v[24:27]
  s_waitcnt vmcnt(4)
  buffer_load_dwordx4 v[100:103], v2, s[40:43], s53 offen offset:1664 nt
  v_and_b32 v68, v64, v4
  v_and_b32 v69, v64, v5
  v_and_b32_dpp v70, v64, v6 row_half_mirror row_mask:0xf bank_mask:0xf
  v_and_b32_dpp v71, v64, v7 row_half_mirror row_mask:0xf bank_mask:0xf
  v_and_b32_dpp v72, v64, v4 row_half_mirror row_mask:0xf bank_mask:0xf
  v_and_b32_dpp v73, v64, v5 row_half_mirror row_mask:0xf bank_mask:0xf
  v_and_b32 v74, v64, v6
  v_and_b32 v75, v64, v7
  s_waitcnt vmcnt(4)
  v_mfma_f32_16x16x32_bf16 v[16:19], v[68:71], v[84:87], v[16:19]
  s_waitcnt vmcnt(4)
  buffer_load_dwordx4 v[104:107], v2, s[40:43], s53 offen offset:1792 nt
  s_add_u32 s53, s53, 6144
  s_waitcnt vmcnt(4)
  v_mfma_f32_16x16x32_bf16 v[20:23], v[68:71], v[88:91], v[20:23]
  s_waitcnt vmcnt(4)
  s_mov_b32 exec_hi, 0x0fffffff
  s_add_u32 m0, s56, 0
  s_nop 0
  buffer_load_dwordx4 v76, s[44:47], s54 offen nt lds
  s_mov_b32 exec_hi, -1
  s_waitcnt vmcnt(4)
  s_mov_b32 exec_hi, 0x0fffffff
  s_add_u32 m0, s56, 960
  s_add_u32 s54, s54, 7680
  buffer_load_dwordx4 v76, s[44:47], s54 offen nt lds
  s_mov_b32 exec_hi, -1
  s_waitcnt vmcnt(4)
  s_mov_b32 exec_hi, 0x0fffffff
  s_add_u32 m0, s56, 1920
  s_add_u32 s54, s54, 7680
  buffer_load_dwordx4 v76, s[44:47], s54 offen nt lds
  s_mov_b32 exec_hi, -1
  s_waitcnt vmcnt(4)
  s_mov_b32 exec_hi, 0x0fffffff
  s_add_u32 m0, s56, 2880
  s_add_u32 s54, s54, 7680
  buffer_load_dwordx4 v76, s[44:47], s54 offen nt lds
  s_mov_b32 exec_hi, -1
  s_waitcnt vmcnt(4)
  buffer_load_dwordx4 v[108:111], v2, s[40:43], s53 offen offset:0 nt
  s_waitcnt vmcnt(8)
  v_mfma_f32_16x16x32_bf16 v[24:27], v[68:71], v[92:95], v[24:27]
  s_waitcnt vmcnt(4)
  buffer_load_dwordx4 v[112:115], v2, s[40:43], s53 offen offset:128 nt
  s_waitcnt vmcnt(9)
  buffer_load_dwordx4 v[116:119], v2, s[40:43], s53 offen offset:256 nt
  s_waitcnt vmcnt(9)
  buffer_load_dwordx4 v[120:123], v2, s[40:43], s53 offen offset:1536 nt
  s_waitcnt vmcnt(9)
  buffer_load_dwordx4 v[124:127], v2, s[40:43], s53 offen offset:1664 nt
  s_waitcnt vmcnt(9)
  buffer_load_dwordx4 v[128:131], v2, s[40:43], s53 offen offset:1792 nt
  s_add_u32 s53, s53, 6144
  s_waitcnt vmcnt(9)
  buffer_load_dwordx4 v[132:135], v2, s[40:43], s53 offen offset:0 nt
  v_mfma_f32_16x16x32_bf16 v[16:19], v[72:75], v[96:99], v[16:19]
  s_waitcnt vmcnt(9)
  buffer_load_dwordx4 v[136:139], v2, s[40:43], s53 offen offset:128 nt
  v_mfma_f32_16x16x32_bf16 v[20:23], v[72:75], v[100:103], v[20:23]
  s_waitcnt vmcnt(9)
  buffer_load_dwordx4 v[140:143], v2, s[40:43], s53 offen offset:256 nt
  v_mfma_f32_16x16x32_bf16 v[24:27], v[72:75], v[104:107], v[24:27]
  s_waitcnt vmcnt(9)
  buffer_load_dwordx4 v[144:147], v2, s[40:43], s53 offen offset:1536 nt
  v_and_b32 v68, v65, v4
  v_and_b32 v69, v65, v5
  v_and_b32_dpp v70, v65, v6 row_half_mirror row_mask:0xf bank_mask:0xf
  v_and_b32_dpp v71, v65, v7 row_half_mirror row_mask:0xf bank_mask:0xf
  v_and_b32_dpp v72, v65, v4 row_half_mirror row_mask:0xf bank_mask:0xf
  v_and_b32_dpp v73, v65, v5 row_half_mirror row_mask:0xf bank_mask:0xf
  v_and_b32 v74, v65, v6
  v_and_b32 v75, v65, v7
  s_waitcnt vmcnt(9)
  v_mfma_f32_16x16x32_bf16 v[16:19], v[68:71], v[108:111], v[16:19]
  s_waitcnt vmcnt(9)
  buffer_load_dwordx4 v[148:151], v2, s[40:43], s53 offen offset:1664 nt
  s_waitcnt vmcnt(9)
  v_mfma_f32_16x16x32_bf16 v[20:23], v[68:71], v[112:115], v[20:23]
  s_waitcnt vmcnt(9)
  buffer_load_dwordx4 v[152:155], v2, s[40:43], s53 offen offset:1792 nt
  s_add_u32 s53, s53, 6144
  s_waitcnt vmcnt(9)
  v_mfma_f32_16x16x32_bf16 v[24:27], v[68:71], v[116:119], v[24:27]
  s_waitcnt vmcnt(9)
  buffer_load_dwordx4 v[156:159], v2, s[40:43], s53 offen offset:0 nt
  s_waitcnt vmcnt(9)
  v_mfma_f32_16x16x32_bf16 v[16:19], v[72:75], v[120:123], v[16:19]
  s_waitcnt vmcnt(9)
  buffer_load_dwordx4 v[160:163], v2, s[40:43], s53 offen offset:128 nt
  s_waitcnt vmcnt(9)
  v_mfma_f32_16x16x32_bf16 v[20:23], v[72:75], v[124:127], v[20:23]
  s_waitcnt vmcnt(9)
  buffer_load_dwordx4 v[164:167], v2, s[40:43], s53 offen offset:256 nt
  s_waitcnt vmcnt(9)
  v_mfma_f32_16x16x32_bf16 v[24:27], v[72:75], v[128:131], v[24:27]
  s_waitcnt vmcnt(9)
  buffer_load_dwordx4 v[168:171], v2, s[40:43], s53 offen offset:1536 nt
  v_and_b32 v68, v66, v4
  v_and_b32 v69, v66, v5
  v_and_b32_dpp v70, v66, v6 row_half_mirror row_mask:0xf bank_mask:0xf
  v_and_b32_dpp v71, v66, v7 row_half_mirror row_mask:0xf bank_mask:0xf
  v_and_b32_dpp v72, v66, v4 row_half_mirror row_mask:0xf bank_mask:0xf
  v_and_b32_dpp v73, v66, v5 row_half_mirror row_mask:0xf bank_mask:0xf
  v_and_b32 v74, v66, v6
  v_and_b32 v75, v66, v7
  s_waitcnt vmcnt(9)
  v_mfma_f32_16x16x32_bf16 v[16:19], v[68:71], v[132:135], v[16:19]
  s_waitcnt vmcnt(9)
  buffer_load_dwordx4 v[172:175], v2, s[40:43], s53 offen offset:1664 nt
  s_waitcnt vmcnt(9)
  v_mfma_f32_16x16x32_bf16 v[20:23], v[68:71], v[136:139], v[20:23]
  s_waitcnt vmcnt(9)
  buffer_load_dwordx4 v[176:179], v2, s[40:43], s53 offen offset:1792 nt
  s_waitcnt vmcnt(9)
  v_mfma_f32_16x16x32_bf16 v[24:27], v[68:71], v[140:143], v[24:27]
  s_waitcnt vmcnt(9)
  s_mov_b32 exec_hi, 0x0fffffff
  s_add_u32 m0, s56, 3840
  s_add_u32 s54, s54, 7680
  buffer_load_dwordx4 v76, s[44:47], s54 offen nt lds
  s_mov_b32 exec_hi, -1
  s_waitcnt vmcnt(9)
  v_mfma_f32_16x16x32_bf16 v[16:19], v[72:75], v[144:147], v[16:19]
  s_waitcnt vmcnt(9)
  s_mov_b32 exec_hi, 0x0fffffff
  s_add_u32 m0, s56, 4800
  s_add_u32 s54, s54, 7680
  buffer_load_dwordx4 v76, s[44:47], s54 offen nt lds
  s_mov_b32 exec_hi, -1
  s_waitcnt vmcnt(9)
  v_mfma_f32_16x16x32_bf16 v[20:23], v[72:75], v[148:151], v[20:23]
  s_waitcnt vmcnt(9)
  s_mov_b32 exec_hi, 0x0fffffff
  s_add_u32 m0, s56, 5760
  s_add_u32 s54, s54, 7680
  buffer_load_dwordx4 v76, s[44:47], s54 offen nt lds
  s_mov_b32 exec_hi, -1
  s_waitcnt vmcnt(9)
  v_mfma_f32_16x16x32_bf16 v[24:27], v[72:75], v[152:155], v[24:27]
  s_waitcnt vmcnt(9)
  s_mov_b32 exec_hi, 0x0fffffff
  s_add_u32 m0, s56, 6720
  s_add_u32 s54, s54, 7680
  buffer_load_dwordx4 v76, s[44:47], s54 offen nt lds
  s_mov_b32 exec_hi, -1
  v_and_b32 v68, v67, v4
  v_and_b32 v69, v67, v5
  v_and_b32_dpp v70, v67, v6 row_half_mirror row_mask:0xf bank_mask:0xf
  v_and_b32_dpp v71, v67, v7 row_half_mirror row_mask:0xf bank_mask:0xf
  v_and_b32_dpp v72, v67, v4 row_half_mirror row_mask:0xf bank_mask:0xf
  v_and_b32_dpp v73, v67, v5 row_half_mirror row_mask:0xf bank_mask:0xf
  v_and_b32 v74, v67, v6
  v_and_b32 v75, v67, v7
  s_waitcnt vmcnt(9)
  v_mfma_f32_16x16x32_bf16 v[16:19], v[68:71], v[156:159], v[16:19]
  s_waitcnt vmcnt(8)
  v_mfma_f32_16x16x32_bf16 v[20:23], v[68:71], v[160:163], v[20:23]
  s_waitcnt vmcnt(7)
  v_mfma_f32_16x16x32_bf16 v[24:27], v[68:71], v[164:167], v[24:27]
  s_waitcnt vmcnt(6)
  v_mfma_f32_16x16x32_bf16 v[16:19], v[72:75], v[168:171], v[16:19]
  s_waitcnt vmcnt(5)
  v_mfma_f32_16x16x32_bf16 v[20:23], v[72:75], v[172:175], v[20:23]
  s_waitcnt vmcnt(4)
  v_mfma_f32_16x16x32_bf16 v[24:27], v[72:75], v[176:179], v[24:27]
  s_mov_b32 exec_lo, 0x00ff00ff
  s_mov_b32 exec_hi, 0xff00ff00
  s_nop 5
  ds_write_b128 v77, v[16:19] offset:3840
  ds_write_b128 v77, v[20:23] offset:4096
  ds_write_b128 v77, v[24:27] offset:4352
  s_mov_b64 exec, -1
  s_waitcnt lgkmcnt(0)
  s_barrier
L_WO_PRE:
  v_bfe_u32 v1, v0, 1, 1
  v_mul_u32_u24 v1, 384, v1
  v_lshrrev_b32 v2, 4, v0
  v_lshl_add_u32 v1, v2, 4, v1
  v_lshrrev_b32 v2, 2, v0
  v_mul_u32_u24 v2, 160, v2
  v_and_b32 v3, 3, v0
  v_lshl_add_u32 v2, v3, 3, v2
  s_lshl_b32 s48, s55, 5
  v_add_u32 v2, s48, v2
  v_lshlrev_b32 v3, 4, v0
  s_mul_i32 s48, s59, 5
  s_add_u32 s48, s48, s55
  s_lshl_b32 s48, s48, 5
  s_add_u32 s48, s48, s58
  s_lshl_b32 s48, s48, 8
  s_add_u32 s48, s48, 1085440
  s_cmp_eq_u32 s55, 4
  s_cbranch_scc1 L_WO_B3
  s_waitcnt vmcnt(0)
L_WO_B3:
  s_barrier
  ds_read_b128 v[96:99], v1 offset:2560
  ds_read_b64_tr_b16 v[100:101], v2 offset:11520
  ds_read_b64_tr_b16 v[102:103], v2 offset:14080
  ds_read_b128 v[104:107], v1 offset:2624
  ds_read_b64_tr_b16 v[108:109], v2 offset:16640
  ds_read_b64_tr_b16 v[110:111], v2 offset:19200
  ds_read_b128 v[112:115], v1 offset:2688
  ds_read_b64_tr_b16 v[116:117], v2 offset:21760
  ds_read_b64_tr_b16 v[118:119], v2 offset:24320
  ds_read_b128 v[120:123], v1 offset:2752
  ds_read_b64_tr_b16 v[124:125], v2 offset:26880
  ds_read_b64_tr_b16 v[126:127], v2 offset:29440
  ds_read_b128 v[128:131], v1 offset:2816
  ds_read_b64_tr_b16 v[132:133], v2 offset:32000
  ds_read_b64_tr_b16 v[134:135], v2 offset:34560
  ds_read_b128 v[136:139], v1 offset:2880
  ds_read_b64_tr_b16 v[140:141], v2 offset:37120
  ds_read_b64_tr_b16 v[142:143], v2 offset:39680
  s_waitcnt lgkmcnt(15)
  v_mfma_f32_16x16x32_bf16 v[8:11], v[96:99], v[100:103], 0
  s_waitcnt lgkmcnt(12)
  v_mfma_f32_16x16x32_bf16 v[8:11], v[104:107], v[108:111], v[8:11]
  s_waitcnt lgkmcnt(9)
  v_mfma_f32_16x16x32_bf16 v[8:11], v[112:115], v[116:119], v[8:11]
  s_waitcnt lgkmcnt(6)
  v_mfma_f32_16x16x32_bf16 v[8:11], v[120:123], v[124:127], v[8:11]
  s_waitcnt lgkmcnt(3)
  v_mfma_f32_16x16x32_bf16 v[8:11], v[128:131], v[132:135], v[8:11]
  s_waitcnt lgkmcnt(0)
  v_mfma_f32_16x16x32_bf16 v[8:11], v[136:139], v[140:143], v[8:11]
  s_mov_b32 exec_lo, 0xffff
  s_mov_b32 exec_hi, 0
  s_nop 5
  v_mov_b32 v9, s31
  v_mov_b32 v11, s31
  buffer_store_dwordx4 v[8:11], v3, s[32:35], s48 offen sc1
L_fin:
L_end:
  s_endpgm
L_HELP:
  v_lshrrev_b32 v3, 5, v0
  v_and_b32 v4, 31, v0
  v_mul_u32_u24 v3, 1280, v3
  v_lshl_add_u32 v1, v4, 4, v3
  v_lshl_add_u32 v2, v4, 3, v3
  v_lshrrev_b32 v5, 3, v0
  v_and_b32 v6, 7, v0
  v_lshlrev_b32 v6, 4, v6
  s_and_b32 s48, s2, 7
  s_lshr_b32 s49, s2, 3
  s_lshr_b32 s62, s49, 3
  s_lshl2_add_u32 s62, s48, s62
  s_and_b32 s63, s49, 7
  s_lshr_b32 s49, s2, 3
  s_sub_u32 s51, s49, 15
  s_cmp_ge_u32 s49, 15
  s_cselect_b32 s49, s51, s49
  s_mul_i32 s57, s49, 13108
  s_lshr_b32 s57, s57, 16
  s_mul_i32 s52, s57, 5
  s_sub_u32 s52, s49, s52
  s_mul_i32 s55, s63, 160
  s_lshl_b32 s54, s52, 8
  s_cmp_eq_u32 s3, 3
  s_cselect_b32 s55, s54, s55
  v_mul_u32_u24 v7, 12288, v5
  v_add_u32 v7, v7, v6
  s_mul_i32 s53, s63, 983040
  s_mul_i32 s54, s62, 384
  s_add_u32 s53, s53, s54
  s_lshl_b32 s54, s3, 7
  s_add_u32 s53, s53, s54
  s_mov_b32 s46, 2560
  s_mov_b32 s47, 0x20000
  s_mov_b32 s38, 7864320
  s_mov_b32 s39, 0x20000
  s_waitcnt lgkmcnt(0)
  s_mov_b32 s44, s4
  s_mov_b32 s45, s5
  buffer_load_dwordx4 v[8:11], v1, s[44:47], 0 offen
  buffer_load_dwordx4 v[12:15], v1, s[44:47], 0 offen offset:512
  buffer_load_dwordx2 v[16:17], v2, s[44:47], 0 offen offset:1024
  buffer_load_dwordx2 v[18:19], v2, s[44:47], s55 offen
  s_mov_b32 s36, s10
  s_mov_b32 s37, s11
  s_cmp_eq_u32 s3, 3
  s_cbranch_scc1 L_LN
  buffer_load_dwordx4 v[96:99], v7, s[36:39], s53 offen nt
  s_add_u32 s53, s53, 98304
  buffer_load_dwordx4 v[100:103], v7, s[36:39], s53 offen nt
  s_add_u32 s53, s53, 98304
  buffer_load_dwordx4 v[104:107], v7, s[36:39], s53 offen nt
  s_add_u32 s53, s53, 98304
  buffer_load_dwordx4 v[108:111], v7, s[36:39], s53 offen nt
  s_add_u32 s53, s53, 98304
  buffer_load_dwordx4 v[112:115], v7, s[36:39], s53 offen nt
  s_add_u32 s53, s53, 98304
  buffer_load_dwordx4 v[116:119], v7, s[36:39], s53 offen nt
  s_add_u32 s53, s53, 98304
  buffer_load_dwordx4 v[120:123], v7, s[36:39], s53 offen nt
  s_add_u32 s53, s53, 98304
  buffer_load_dwordx4 v[124:127], v7, s[36:39], s53 offen nt
  s_add_u32 s53, s53, 98304
  buffer_load_dwordx4 v[128:131], v7, s[36:39], s53 offen nt
  s_add_u32 s53, s53, 98304
  buffer_load_dwordx4 v[132:135], v7, s[36:39], s53 offen nt
L_LN:
  s_load_dword s31, s[26:27], 0
  s_mov_b32 s32, s26
  s_mov_b32 s33, s27
  s_mov_b32 s34, 402653184
  s_mov_b32 s35, 0x20000
  v_and_b32 v20, 1, v0
  v_lshlrev_b32 v20, 4, v20
  s_mov_b32 s48, 0xffff
  v_lshlrev_b32_e64 v20, v20, s48
  s_mov_b32 s48, 0x03030303
  s_mov_b32 s49, s48
  v_cndmask_b32_e64 v88, 0, v20, s[48:49]
  s_mov_b32 s48, 0x0c0c0c0c
  s_mov_b32 s49, s48
  v_cndmask_b32_e64 v89, 0, v20, s[48:49]
  s_mov_b32 s48, 0x30303030
  s_mov_b32 s49, s48
  v_cndmask_b32_e64 v90, 0, v20, s[48:49]
  s_mov_b32 s48, 0xc0c0c0c0
  s_mov_b32 s49, s48
  v_cndmask_b32_e64 v91, 0, v20, s[48:49]
  s_cmp_eq_u32 s3, 3
  s_cselect_b32 s54, 1024, 0
  v_lshrrev_b32 v21, 5, v0
  v_lshlrev_b32 v21, 9, v21
  v_and_b32 v22, 1, v0
  v_lshl_add_u32 v21, v22, 8, v21
  v_bfe_u32 v22, v0, 1, 4
  v_lshl_add_u32 v21, v22, 2, v21
  v_add_u32 v21, s54, v21
  v_lshl_add_u32 v22, v5, 6, s54
  v_mov_b32 v23, 0
  v_lshlrev_b32 v24, 2, v0
  v_and_b32 v24, 127, v24
  ds_write_b32 v24, v23 offset:2432
  s_cbranch_scc0 L_LN_GO
  s_waitcnt vmcnt(0)
L_LN_GO:
  s_waitcnt vmcnt(10)
  v_lshlrev_b32 v24, 16, v8
  v_and_b32 v25, 0xffff0000, v8
  v_lshlrev_b32 v26, 16, v9
  v_and_b32 v27, 0xffff0000, v9
  v_lshlrev_b32 v28, 16, v10
  v_and_b32 v29, 0xffff0000, v10
  v_lshlrev_b32 v30, 16, v11
  v_and_b32 v31, 0xffff0000, v11
  v_lshlrev_b32 v32, 16, v12
  v_and_b32 v33, 0xffff0000, v12
  v_lshlrev_b32 v34, 16, v13
  v_and_b32 v35, 0xffff0000, v13
  v_lshlrev_b32 v36, 16, v14
  v_and_b32 v37, 0xffff0000, v14
  v_lshlrev_b32 v38, 16, v15
  v_and_b32 v39, 0xffff0000, v15
  v_lshlrev_b32 v40, 16, v16
  v_and_b32 v41, 0xffff0000, v16
  v_lshlrev_b32 v42, 16, v17
  v_and_b32 v43, 0xffff0000, v17
  v_pk_add_f32 v[60:61], v[24:25], v[26:27]
  v_pk_add_f32 v[60:61], v[60:61], v[28:29]
  v_pk_add_f32 v[60:61], v[60:61], v[30:31]
  v_pk_add_f32 v[60:61], v[60:61], v[32:33]
  v_pk_add_f32 v[60:61], v[60:61], v[34:35]
  v_pk_add_f32 v[60:61], v[60:61], v[36:37]
  v_pk_add_f32 v[60:61], v[60:61], v[38:39]
  v_pk_add_f32 v[60:61], v[60:61], v[40:41]
  v_pk_add_f32 v[60:61], v[60:61], v[42:43]
  v_add_f32 v60, v60, v61
  s_nop 1
  v_add_f32_dpp v60, v60, v60 row_ror:8 row_mask:0xf bank_mask:0xf
  s_nop 1
  v_add_f32_dpp v60, v60, v60 row_ror:4 row_mask:0xf bank_mask:0xf
  s_nop 1
  v_add_f32_dpp v60, v60, v60 row_ror:2 row_mask:0xf bank_mask:0xf
  s_nop 1
  v_add_f32_dpp v60, v60, v60 row_ror:1 row_mask:0xf bank_mask:0xf
  v_mov_b32 v61, v60
  s_nop 1
  v_permlane16_swap_b32 v61, v60
  v_add_f32 v60, v60, v61
  v_mul_f32 v60, 0x3acccccd, v60
  v_pk_add_f32 v[24:25], v[24:25], v[60:61] op_sel_hi:[1,0] neg_lo:[0,1] neg_hi:[0,1]
  v_pk_add_f32 v[26:27], v[26:27], v[60:61] op_sel_hi:[1,0] neg_lo:[0,1] neg_hi:[0,1]
  v_pk_add_f32 v[28:29], v[28:29], v[60:61] op_sel_hi:[1,0] neg_lo:[0,1] neg_hi:[0,1]
  v_pk_add_f32 v[30:31], v[30:31], v[60:61] op_sel_hi:[1,0] neg_lo:[0,1] neg_hi:[0,1]
  v_pk_add_f32 v[32:33], v[32:33], v[60:61] op_sel_hi:[1,0] neg_lo:[0,1] neg_hi:[0,1]
  v_pk_add_f32 v[34:35], v[34:35], v[60:61] op_sel_hi:[1,0] neg_lo:[0,1] neg_hi:[0,1]
  v_pk_add_f32 v[36:37], v[36:37], v[60:61] op_sel_hi:[1,0] neg_lo:[0,1] neg_hi:[0,1]
  v_pk_add_f32 v[38:39], v[38:39], v[60:61] op_sel_hi:[1,0] neg_lo:[0,1] neg_hi:[0,1]
  v_pk_add_f32 v[40:41], v[40:41], v[60:61] op_sel_hi:[1,0] neg_lo:[0,1] neg_hi:[0,1]
  v_pk_add_f32 v[42:43], v[42:43], v[60:61] op_sel_hi:[1,0] neg_lo:[0,1] neg_hi:[0,1]
  v_pk_mul_f32 v[62:63], v[24:25], v[24:25]
  v_pk_fma_f32 v[62:63], v[26:27], v[26:27], v[62:63]
  v_pk_fma_f32 v[62:63], v[28:29], v[28:29], v[62:63]
  v_pk_fma_f32 v[62:63], v[30:31], v[30:31], v[62:63]
  v_pk_fma_f32 v[62:63], v[32:33], v[32:33], v[62:63]
  v_pk_fma_f32 v[62:63], v[34:35], v[34:35], v[62:63]
  v_pk_fma_f32 v[62:63], v[36:37], v[36:37], v[62:63]
  v_pk_fma_f32 v[62:63], v[38:39], v[38:39], v[62:63]
  v_pk_fma_f32 v[62:63], v[40:41], v[40:41], v[62:63]
  v_pk_fma_f32 v[62:63], v[42:43], v[42:43], v[62:63]
  v_add_f32 v62, v62, v63
  s_nop 1
  v_add_f32_dpp v62, v62, v62 row_ror:8 row_mask:0xf bank_mask:0xf
  s_nop 1
  v_add_f32_dpp v62, v62, v62 row_ror:4 row_mask:0xf bank_mask:0xf
  s_nop 1
  v_add_f32_dpp v62, v62, v62 row_ror:2 row_mask:0xf bank_mask:0xf
  s_nop 1
  v_add_f32_dpp v62, v62, v62 row_ror:1 row_mask:0xf bank_mask:0xf
  v_mov_b32 v63, v62
  s_nop 1
  v_permlane16_swap_b32 v63, v62
  v_add_f32 v62, v62, v63
  v_mul_f32 v62, 0x3acccccd, v62
  v_cvt_pk_bf16_f32 v60, v60, v60
  v_and_b32 v60, 0xffff0000, v60
  v_cvt_pk_bf16_f32 v62, v62, v62
  v_and_b32 v62, 0xffff0000, v62
  v_add_f32 v62, 0x3727c5ac, v62
  v_cvt_pk_bf16_f32 v62, v62, v62
  v_and_b32 v62, 0xffff0000, v62
  v_sqrt_f32 v62, v62
  v_lshlrev_b32 v56, 16, v18
  v_and_b32 v57, 0xffff0000, v18
  v_cvt_pk_bf16_f32 v62, v62, v62
  v_and_b32 v62, 0xffff0000, v62
  v_rcp_f32 v62, v62
  v_lshlrev_b32 v58, 16, v19
  v_and_b32 v59, 0xffff0000, v19
  v_sub_f32 v56, v56, v60
  v_sub_f32 v57, v57, v60
  v_sub_f32 v58, v58, v60
  v_sub_f32 v59, v59, v60
  v_cvt_pk_bf16_f32 v18, v56, v57
  v_cvt_pk_bf16_f32 v19, v58, v59
  v_lshlrev_b32 v56, 16, v18
  v_and_b32 v57, 0xffff0000, v18
  v_lshlrev_b32 v58, 16, v19
  v_and_b32 v59, 0xffff0000, v19
  v_mul_f32 v56, v56, v62
  v_mul_f32 v57, v57, v62
  v_mul_f32 v58, v58, v62
  v_mul_f32 v59, v59, v62
  v_cvt_pk_bf16_f32 v56, v56, v56
  ds_write_b32 v21, v56 offset:0
  v_cvt_pk_bf16_f32 v57, v57, v57
  ds_write_b32 v21, v57 offset:64
  v_cvt_pk_bf16_f32 v58, v58, v58
  ds_write_b32 v21, v58 offset:128
  v_cvt_pk_bf16_f32 v59, v59, v59
  ds_write_b32 v21, v59 offset:192
  ds_read_b128 v[24:27], v22 offset:0
  ds_read_b128 v[40:43], v22 offset:512
  ds_read_b128 v[28:31], v22 offset:16
  ds_read_b128 v[44:47], v22 offset:528
  ds_read_b128 v[32:35], v22 offset:32
  ds_read_b128 v[48:51], v22 offset:544
  ds_read_b128 v[36:39], v22 offset:48
  ds_read_b128 v[52:55], v22 offset:560
  v_and_b32 v18, 7, v0
  v_lshlrev_b32 v18, 6, v18
  v_bfe_u32 v19, v0, 4, 1
  v_lshl_add_u32 v18, v19, 5, v18
  v_lshrrev_b32 v19, 5, v0
  v_lshl_add_u32 v18, v19, 4, v18
  v_bfe_u32 v20, v0, 3, 1
  v_lshlrev_b32 v19, 4, v0
  s_waitcnt lgkmcnt(0)
  s_add_u32 s31, s31, 0x9e3779b1
  s_cmp_eq_u32 s3, 3
  s_cbranch_scc1 L_H_B1
  v_and_b32 v72, v24, v88
  v_and_b32 v73, v24, v89
  v_and_b32 v74, v24, v90
  v_and_b32 v75, v24, v91
  v_and_b32 v76, v40, v88
  v_and_b32 v77, v40, v89
  v_and_b32 v78, v40, v90
  v_and_b32 v79, v40, v91
  s_waitcnt vmcnt(9)
  v_mfma_f32_16x16x32_bf16 v[64:67], v[72:75], v[96:99], 0
  v_mfma_f32_16x16x32_bf16 v[68:71], v[76:79], v[96:99], 0
  v_and_b32 v72, v25, v88
  v_and_b32 v73, v25, v89
  v_and_b32 v74, v25, v90
  v_and_b32 v75, v25, v91
  v_and_b32 v76, v41, v88
  v_and_b32 v77, v41, v89
  v_and_b32 v78, v41, v90
  v_and_b32 v79, v41, v91
  s_waitcnt vmcnt(8)
  v_mfma_f32_16x16x32_bf16 v[64:67], v[72:75], v[100:103], v[64:67]
  v_mfma_f32_16x16x32_bf16 v[68:71], v[76:79], v[100:103], v[68:71]
  v_and_b32 v72, v26, v88
  v_and_b32 v73, v26, v89
  v_and_b32 v74, v26, v90
  v_and_b32 v75, v26, v91
  v_and_b32 v76, v42, v88
  v_and_b32 v77, v42, v89
  v_and_b32 v78, v42, v90
  v_and_b32 v79, v42, v91
  s_waitcnt vmcnt(7)
  v_mfma_f32_16x16x32_bf16 v[64:67], v[72:75], v[104:107], v[64:67]
  v_mfma_f32_16x16x32_bf16 v[68:71], v[76:79], v[104:107], v[68:71]
  v_and_b32 v72, v27, v88
  v_and_b32 v73, v27, v89
  v_and_b32 v74, v27, v90
  v_and_b32 v75, v27, v91
  v_and_b32 v76, v43, v88
  v_and_b32 v77, v43, v89
  v_and_b32 v78, v43, v90
  v_and_b32 v79, v43, v91
  s_waitcnt vmcnt(6)
  v_mfma_f32_16x16x32_bf16 v[64:67], v[72:75], v[108:111], v[64:67]
  v_mfma_f32_16x16x32_bf16 v[68:71], v[76:79], v[108:111], v[68:71]
  v_and_b32 v72, v28, v88
  v_and_b32 v73, v28, v89
  v_and_b32 v74, v28, v90
  v_and_b32 v75, v28, v91
  v_and_b32 v76, v44, v88
  v_and_b32 v77, v44, v89
  v_and_b32 v78, v44, v90
  v_and_b32 v79, v44, v91
  s_waitcnt vmcnt(5)
  v_mfma_f32_16x16x32_bf16 v[64:67], v[72:75], v[112:115], v[64:67]
  v_mfma_f32_16x16x32_bf16 v[68:71], v[76:79], v[112:115], v[68:71]
  v_and_b32 v72, v29, v88
  v_and_b32 v73, v29, v89
  v_and_b32 v74, v29, v90
  v_and_b32 v75, v29, v91
  v_and_b32 v76, v45, v88
  v_and_b32 v77, v45, v89
  v_and_b32 v78, v45, v90
  v_and_b32 v79, v45, v91
  s_waitcnt vmcnt(4)
  v_mfma_f32_16x16x32_bf16 v[64:67], v[72:75], v[116:119], v[64:67]
  v_mfma_f32_16x16x32_bf16 v[68:71], v[76:79], v[116:119], v[68:71]
  v_and_b32 v72, v30, v88
  v_and_b32 v73, v30, v89
  v_and_b32 v74, v30, v90
  v_and_b32 v75, v30, v91
  v_and_b32 v76, v46, v88
  v_and_b32 v77, v46, v89
  v_and_b32 v78, v46, v90
  v_and_b32 v79, v46, v91
  s_waitcnt vmcnt(3)
  v_mfma_f32_16x16x32_bf16 v[64:67], v[72:75], v[120:123], v[64:67]
  v_mfma_f32_16x16x32_bf16 v[68:71], v[76:79], v[120:123], v[68:71]
  v_and_b32 v72, v31, v88
  v_and_b32 v73, v31, v89
  v_and_b32 v74, v31, v90
  v_and_b32 v75, v31, v91
  v_and_b32 v76, v47, v88
  v_and_b32 v77, v47, v89
  v_and_b32 v78, v47, v90
  v_and_b32 v79, v47, v91
  s_waitcnt vmcnt(2)
  v_mfma_f32_16x16x32_bf16 v[64:67], v[72:75], v[124:127], v[64:67]
  v_mfma_f32_16x16x32_bf16 v[68:71], v[76:79], v[124:127], v[68:71]
  v_and_b32 v72, v32, v88
  v_and_b32 v73, v32, v89
  v_and_b32 v74, v32, v90
  v_and_b32 v75, v32, v91
  v_and_b32 v76, v48, v88
  v_and_b32 v77, v48, v89
  v_and_b32 v78, v48, v90
  v_and_b32 v79, v48, v91
  s_waitcnt vmcnt(1)
  v_mfma_f32_16x16x32_bf16 v[64:67], v[72:75], v[128:131], v[64:67]
  v_mfma_f32_16x16x32_bf16 v[68:71], v[76:79], v[128:131], v[68:71]
  v_and_b32 v72, v33, v88
  v_and_b32 v73, v33, v89
  v_and_b32 v74, v33, v90
  v_and_b32 v75, v33, v91
  v_and_b32 v76, v49, v88
  v_and_b32 v77, v49, v89
  v_and_b32 v78, v49, v90
  v_and_b32 v79, v49, v91
  s_waitcnt vmcnt(0)
  v_mfma_f32_16x16x32_bf16 v[64:67], v[72:75], v[132:135], v[64:67]
  v_mfma_f32_16x16x32_bf16 v[68:71], v[76:79], v[132:135], v[68:71]
  s_mul_i32 s54, s62, 3
  s_add_u32 s54, s54, s3
  s_lshl_b32 s54, s54, 13
  s_lshl_b32 s60, s63, 9
  s_add_u32 s54, s54, s60
  s_add_u32 s54, s54, 36864
  s_mul_i32 s53, s28, 3
  s_add_u32 s53, s53, s3
  s_lshl_b32 s53, s53, 13
  s_lshl_b32 s60, s30, 12
  s_add_u32 s53, s53, s60
  s_add_u32 s53, s53, 36864
  v_lshl_add_u32 v21, v20, 12, v18
  v_permlane32_swap_b32 v64, v66
  v_permlane32_swap_b32 v68, v70
  v_permlane32_swap_b32 v65, v67
  v_permlane32_swap_b32 v69, v71
  v_mov_b32 v81, s31
  v_mov_b32 v83, s31
  v_add_f32_dpp v80, v66, v64 row_shl:8 row_mask:0xf bank_mask:0xf
  v_add_f32_dpp v82, v67, v65 row_shl:8 row_mask:0xf bank_mask:0xf
  v_add_f32_dpp v80, v68, v70 row_shr:8 row_mask:0xf bank_mask:0xf
  v_add_f32_dpp v82, v69, v71 row_shr:8 row_mask:0xf bank_mask:0xf
  s_getreg_b32 s61, hwreg(HW_REG_XCC_ID)
  s_and_b32 s61, s61, 15
  s_xor_b32 s61, s61, s31
  v_mov_b32 v83, s61
  buffer_store_dwordx4 v[80:83], v21, s[32:35], s54 offen
  s_sleep 20
  s_mov_b32 s50, 0
  s_mov_b32 s57, 0
L_QPOLL:
  buffer_load_dwordx4 v[24:27], v19, s[32:35], s53 offen offset:0 sc1
  buffer_load_dwordx4 v[28:31], v19, s[32:35], s53 offen offset:1024 sc1
  buffer_load_dwordx4 v[32:35], v19, s[32:35], s53 offen offset:2048 sc1
  buffer_load_dwordx4 v[36:39], v19, s[32:35], s53 offen offset:3072 sc1
  s_add_u32 s50, s50, 1
  s_waitcnt vmcnt(0)
  v_xor_b32 v25, s31, v25
  v_xor_b32 v27, s61, v27
  v_xor_b32 v29, s31, v29
  v_xor_b32 v31, s61, v31
  v_xor_b32 v33, s31, v33
  v_xor_b32 v35, s61, v35
  v_xor_b32 v37, s31, v37
  v_xor_b32 v39, s61, v39
  v_or3_b32 v8, v25, v29, v33
  v_or3_b32 v9, v27, v31, v35
  v_or_b32 v8, v8, v37
  v_or_b32 v9, v9, v39
  v_lshrrev_b32 v10, 4, v9
  v_or_b32 v8, v8, v10
  v_cmp_ne_u32 vcc, 0, v8
  s_cbranch_vccz L_QPOLL_ok
  s_cmp_lg_u32 s50, 6
  s_cbranch_scc1 L_QPOLL_n
  buffer_store_dwordx4 v[80:83], v21, s[32:35], s54 offen sc1
L_QPOLL_n:
  s_cmp_gt_u32 s50, 0x40000
  s_cbranch_scc1 L_QPOLL_x
  s_sleep 12
  s_branch L_QPOLL
L_QPOLL_ok:
  v_cmp_ne_u32 vcc, 0, v9
  s_mov_b32 s57, 1
  s_cbranch_vccz L_QPOLL_x
  s_mov_b32 s57, 0
  buffer_store_dwordx4 v[80:83], v21, s[32:35], s54 offen sc1
L_QPOLL_x:
  v_add_f32 v24, v24, v28
  v_add_f32 v26, v26, v30
  v_add_f32 v24, v24, v32
  v_add_f32 v26, v26, v34
  v_add_f32 v24, v24, v36
  v_add_f32 v26, v26, v38
  v_and_b32 v21, 31, v0
  v_lshlrev_b32 v21, 2, v21
  v_lshrrev_b32 v22, 5, v0
  v_lshl_add_u32 v21, v22, 1, v21
  v_permlane32_swap_b32 v24, v26
  s_lshl_b32 s54, s3, 7
  v_add_f32 v24, v24, v26
  v_add_u32 v21, s54, v21
  v_cvt_pk_bf16_f32 v24, v24, v24
  ds_write_b16 v21, v24 offset:2048
  s_waitcnt lgkmcnt(0)
L_H_B1:
  s_barrier
  s_and_b32 s48, s2, 7
  s_lshr_b32 s49, s2, 3
  s_lshr_b32 s58, s49, 3
  s_lshl2_add_u32 s58, s48, s58
  s_and_b32 s59, s49, 7
  s_cmp_eq_u32 s3, 0
  s_cbranch_scc1 L_H0
  s_cmp_eq_u32 s3, 2
  s_cbranch_scc1 L_H2_PRE
  s_cmp_eq_u32 s3, 1
  s_cbranch_scc1 L_E1G
  s_cmp_ge_u32 s2, 240
  s_cbranch_scc1 L_E1G
  s_cmp_ge_u32 s2, 120
  s_cbranch_scc1 L_G2
  s_add_u32 s48, s2, 0
  s_and_b32 s48, s48, 7
  s_mul_i32 s51, s48, 3
  s_add_u32 s51, s51, s57
  s_mov_b32 s36, s16
  s_mov_b32 s37, s17
  s_mov_b32 s38, 1966080
  s_mov_b32 s39, 0x20000
  s_mov_b32 s40, s18
  s_mov_b32 s41, s19
  s_mov_b32 s42, 1966080
  s_mov_b32 s43, 0x20000
  v_mul_u32_u24 v7, 3072, v5
  v_add_u32 v7, v7, v6
  s_mul_i32 s53, s52, 393216
  s_lshl_b32 s54, s51, 7
  s_add_u32 s53, s53, s54
  buffer_load_dwordx4 v[96:99], v7, s[36:39], s53 offen nt
  buffer_load_dwordx4 v[100:103], v7, s[40:43], s53 offen nt
  s_add_u32 s53, s53, 24576
  buffer_load_dwordx4 v[104:107], v7, s[36:39], s53 offen nt
  buffer_load_dwordx4 v[108:111], v7, s[40:43], s53 offen nt
  s_add_u32 s53, s53, 24576
  s_waitcnt vmcnt(2)
  buffer_load_dwordx4 v[112:115], v7, s[36:39], s53 offen nt
  buffer_load_dwordx4 v[116:119], v7, s[40:43], s53 offen nt
  s_add_u32 s53, s53, 24576
  v_and_b32 v72, v24, v88
  v_and_b32 v73, v24, v89
  v_and_b32 v74, v24, v90
  v_and_b32 v75, v24, v91
  v_and_b32 v76, v40, v88
  v_and_b32 v77, v40, v89
  v_and_b32 v78, v40, v90
  v_and_b32 v79, v40, v91
  s_nop 1
  v_mfma_f32_16x16x32_bf16 v[64:67], v[72:75], v[96:99], 0
  v_mfma_f32_16x16x32_bf16 v[68:71], v[76:79], v[96:99], 0
  v_mfma_f32_16x16x32_bf16 v[224:227], v[72:75], v[100:103], 0
  v_mfma_f32_16x16x32_bf16 v[228:231], v[76:79], v[100:103], 0
  s_waitcnt vmcnt(2)
  buffer_load_dwordx4 v[120:123], v7, s[36:39], s53 offen nt
  buffer_load_dwordx4 v[124:127], v7, s[40:43], s53 offen nt
  s_add_u32 s53, s53, 24576
  v_and_b32 v72, v25, v88
  v_and_b32 v73, v25, v89
  v_and_b32 v74, v25, v90
  v_and_b32 v75, v25, v91
  v_and_b32 v76, v41, v88
  v_and_b32 v77, v41, v89
  v_and_b32 v78, v41, v90
  v_and_b32 v79, v41, v91
  s_nop 1
  v_mfma_f32_16x16x32_bf16 v[64:67], v[72:75], v[104:107], v[64:67]
  v_mfma_f32_16x16x32_bf16 v[68:71], v[76:79], v[104:107], v[68:71]
  v_mfma_f32_16x16x32_bf16 v[224:227], v[72:75], v[108:111], v[224:227]
  v_mfma_f32_16x16x32_bf16 v[228:231], v[76:79], v[108:111], v[228:231]
  s_waitcnt vmcnt(2)
  buffer_load_dwordx4 v[128:131], v7, s[36:39], s53 offen nt
  buffer_load_dwordx4 v[132:135], v7, s[40:43], s53 offen nt
  s_add_u32 s53, s53, 24576
  v_and_b32 v72, v26, v88
  v_and_b32 v73, v26, v89
  v_and_b32 v74, v26, v90
  v_and_b32 v75, v26, v91
  v_and_b32 v76, v42, v88
  v_and_b32 v77, v42, v89
  v_and_b32 v78, v42, v90
  v_and_b32 v79, v42, v91
  s_nop 1
  v_mfma_f32_16x16x32_bf16 v[64:67], v[72:75], v[112:115], v[64:67]
  v_mfma_f32_16x16x32_bf16 v[68:71], v[76:79], v[112:115], v[68:71]
  v_mfma_f32_16x16x32_bf16 v[224:227], v[72:75], v[116:119], v[224:227]
  v_mfma_f32_16x16x32_bf16 v[228:231], v[76:79], v[116:119], v[228:231]
  s_waitcnt vmcnt(2)
  buffer_load_dwordx4 v[136:139], v7, s[36:39], s53 offen nt
  buffer_load_dwordx4 v[140:143], v7, s[40:43], s53 offen nt
  s_add_u32 s53, s53, 24576
  v_and_b32 v72, v27, v88
  v_and_b32 v73, v27, v89
  v_and_b32 v74, v27, v90
  v_and_b32 v75, v27, v91
  v_and_b32 v76, v43, v88
  v_and_b32 v77, v43, v89
  v_and_b32 v78, v43, v90
  v_and_b32 v79, v43, v91
  s_nop 1
  v_mfma_f32_16x16x32_bf16 v[64:67], v[72:75], v[120:123], v[64:67]
  v_mfma_f32_16x16x32_bf16 v[68:71], v[76:79], v[120:123], v[68:71]
  v_mfma_f32_16x16x32_bf16 v[224:227], v[72:75], v[124:127], v[224:227]
  v_mfma_f32_16x16x32_bf16 v[228:231], v[76:79], v[124:127], v[228:231]
  s_waitcnt vmcnt(2)
  buffer_load_dwordx4 v[144:147], v7, s[36:39], s53 offen nt
  buffer_load_dwordx4 v[148:151], v7, s[40:43], s53 offen nt
  s_add_u32 s53, s53, 24576
  v_and_b32 v72, v28, v88
  v_and_b32 v73, v28, v89
  v_and_b32 v74, v28, v90
  v_and_b32 v75, v28, v91
  v_and_b32 v76, v44, v88
  v_and_b32 v77, v44, v89
  v_and_b32 v78, v44, v90
  v_and_b32 v79, v44, v91
  s_nop 1
  v_mfma_f32_16x16x32_bf16 v[64:67], v[72:75], v[128:131], v[64:67]
  v_mfma_f32_16x16x32_bf16 v[68:71], v[76:79], v[128:131], v[68:71]
  v_mfma_f32_16x16x32_bf16 v[224:227], v[72:75], v[132:135], v[224:227]
  v_mfma_f32_16x16x32_bf16 v[228:231], v[76:79], v[132:135], v[228:231]
  s_waitcnt vmcnt(2)
  buffer_load_dwordx4 v[152:155], v7, s[36:39], s53 offen nt
  buffer_load_dwordx4 v[156:159], v7, s[40:43], s53 offen nt
  s_add_u32 s53, s53, 24576
  v_and_b32 v72, v29, v88
  v_and_b32 v73, v29, v89
  v_and_b32 v74, v29, v90
  v_and_b32 v75, v29, v91
  v_and_b32 v76, v45, v88
  v_and_b32 v77, v45, v89
  v_and_b32 v78, v45, v90
  v_and_b32 v79, v45, v91
  s_nop 1
  v_mfma_f32_16x16x32_bf16 v[64:67], v[72:75], v[136:139], v[64:67]
  v_mfma_f32_16x16x32_bf16 v[68:71], v[76:79], v[136:139], v[68:71]
  v_mfma_f32_16x16x32_bf16 v[224:227], v[72:75], v[140:143], v[224:227]
  v_mfma_f32_16x16x32_bf16 v[228:231], v[76:79], v[140:143], v[228:231]
  s_waitcnt vmcnt(2)
  buffer_load_dwordx4 v[160:163], v7, s[36:39], s53 offen nt
  buffer_load_dwordx4 v[164:167], v7, s[40:43], s53 offen nt
  s_add_u32 s53, s53, 24576
  v_and_b32 v72, v30, v88
  v_and_b32 v73, v30, v89
  v_and_b32 v74, v30, v90
  v_and_b32 v75, v30, v91
  v_and_b32 v76, v46, v88
  v_and_b32 v77, v46, v89
  v_and_b32 v78, v46, v90
  v_and_b32 v79, v46, v91
  s_nop 1
  v_mfma_f32_16x16x32_bf16 v[64:67], v[72:75], v[144:147], v[64:67]
  v_mfma_f32_16x16x32_bf16 v[68:71], v[76:79], v[144:147], v[68:71]
  v_mfma_f32_16x16x32_bf16 v[224:227], v[72:75], v[148:151], v[224:227]
  v_mfma_f32_16x16x32_bf16 v[228:231], v[76:79], v[148:151], v[228:231]
  s_waitcnt vmcnt(2)
  buffer_load_dwordx4 v[168:171], v7, s[36:39], s53 offen nt
  buffer_load_dwordx4 v[172:175], v7, s[40:43], s53 offen nt
  s_add_u32 s53, s53, 24576
  v_and_b32 v72, v31, v88
  v_and_b32 v73, v31, v89
  v_and_b32 v74, v31, v90
  v_and_b32 v75, v31, v91
  v_and_b32 v76, v47, v88
  v_and_b32 v77, v47, v89
  v_and_b32 v78, v47, v90
  v_and_b32 v79, v47, v91
  s_nop 1
  v_mfma_f32_16x16x32_bf16 v[64:67], v[72:75], v[152:155], v[64:67]
  v_mfma_f32_16x16x32_bf16 v[68:71], v[76:79], v[152:155], v[68:71]
  v_mfma_f32_16x16x32_bf16 v[224:227], v[72:75], v[156:159], v[224:227]
  v_mfma_f32_16x16x32_bf16 v[228:231], v[76:79], v[156:159], v[228:231]
  s_waitcnt vmcnt(2)
  buffer_load_dwordx4 v[176:179], v7, s[36:39], s53 offen nt
  buffer_load_dwordx4 v[180:183], v7, s[40:43], s53 offen nt
  s_add_u32 s53, s53, 24576
  v_and_b32 v72, v32, v88
  v_and_b32 v73, v32, v89
  v_and_b32 v74, v32, v90
  v_and_b32 v75, v32, v91
  v_and_b32 v76, v48, v88
  v_and_b32 v77, v48, v89
  v_and_b32 v78, v48, v90
  v_and_b32 v79, v48, v91
  s_nop 1
  v_mfma_f32_16x16x32_bf16 v[64:67], v[72:75], v[160:163], v[64:67]
  v_mfma_f32_16x16x32_bf16 v[68:71], v[76:79], v[160:163], v[68:71]
  v_mfma_f32_16x16x32_bf16 v[224:227], v[72:75], v[164:167], v[224:227]
  v_mfma_f32_16x16x32_bf16 v[228:231], v[76:79], v[164:167], v[228:231]
  s_waitcnt vmcnt(2)
  buffer_load_dwordx4 v[184:187], v7, s[36:39], s53 offen nt
  buffer_load_dwordx4 v[188:191], v7, s[40:43], s53 offen nt
  s_add_u32 s53, s53, 24576
  v_and_b32 v72, v33, v88
  v_and_b32 v73, v33, v89
  v_and_b32 v74, v33, v90
  v_and_b32 v75, v33, v91
  v_and_b32 v76, v49, v88
  v_and_b32 v77, v49, v89
  v_and_b32 v78, v49, v90
  v_and_b32 v79, v49, v91
  s_nop 1
  v_mfma_f32_16x16x32_bf16 v[64:67], v[72:75], v[168:171], v[64:67]
  v_mfma_f32_16x16x32_bf16 v[68:71], v[76:79], v[168:171], v[68:71]
  v_mfma_f32_16x16x32_bf16 v[224:227], v[72:75], v[172:175], v[224:227]
  v_mfma_f32_16x16x32_bf16 v[228:231], v[76:79], v[172:175], v[228:231]
  s_waitcnt vmcnt(2)
  buffer_load_dwordx4 v[192:195], v7, s[36:39], s53 offen nt
  buffer_load_dwordx4 v[196:199], v7, s[40:43], s53 offen nt
  s_add_u32 s53, s53, 24576
  v_and_b32 v72, v34, v88
  v_and_b32 v73, v34, v89
  v_and_b32 v74, v34, v90
  v_and_b32 v75, v34, v91
  v_and_b32 v76, v50, v88
  v_and_b32 v77, v50, v89
  v_and_b32 v78, v50, v90
  v_and_b32 v79, v50, v91
  s_nop 1
  v_mfma_f32_16x16x32_bf16 v[64:67], v[72:75], v[176:179], v[64:67]
  v_mfma_f32_16x16x32_bf16 v[68:71], v[76:79], v[176:179], v[68:71]
  v_mfma_f32_16x16x32_bf16 v[224:227], v[72:75], v[180:183], v[224:227]
  v_mfma_f32_16x16x32_bf16 v[228:231], v[76:79], v[180:183], v[228:231]
  s_waitcnt vmcnt(2)
  buffer_load_dwordx4 v[200:203], v7, s[36:39], s53 offen nt
  buffer_load_dwordx4 v[204:207], v7, s[40:43], s53 offen nt
  s_add_u32 s53, s53, 24576
  v_and_b32 v72, v35, v88
  v_and_b32 v73, v35, v89
  v_and_b32 v74, v35, v90
  v_and_b32 v75, v35, v91
  v_and_b32 v76, v51, v88
  v_and_b32 v77, v51, v89
  v_and_b32 v78, v51, v90
  v_and_b32 v79, v51, v91
  s_nop 1
  v_mfma_f32_16x16x32_bf16 v[64:67], v[72:75], v[184:187], v[64:67]
  v_mfma_f32_16x16x32_bf16 v[68:71], v[76:79], v[184:187], v[68:71]
  v_mfma_f32_16x16x32_bf16 v[224:227], v[72:75], v[188:191], v[224:227]
  v_mfma_f32_16x16x32_bf16 v[228:231], v[76:79], v[188:191], v[228:231]
  s_waitcnt vmcnt(2)
  buffer_load_dwordx4 v[208:211], v7, s[36:39], s53 offen nt
  buffer_load_dwordx4 v[212:215], v7, s[40:43], s53 offen nt
  s_add_u32 s53, s53, 24576
  v_and_b32 v72, v36, v88
  v_and_b32 v73, v36, v89
  v_and_b32 v74, v36, v90
  v_and_b32 v75, v36, v91
  v_and_b32 v76, v52, v88
  v_and_b32 v77, v52, v89
  v_and_b32 v78, v52, v90
  v_and_b32 v79, v52, v91
  s_nop 1
  v_mfma_f32_16x16x32_bf16 v[64:67], v[72:75], v[192:195], v[64:67]
  v_mfma_f32_16x16x32_bf16 v[68:71], v[76:79], v[192:195], v[68:71]
  v_mfma_f32_16x16x32_bf16 v[224:227], v[72:75], v[196:199], v[224:227]
  v_mfma_f32_16x16x32_bf16 v[228:231], v[76:79], v[196:199], v[228:231]
  s_waitcnt vmcnt(2)
  buffer_load_dwordx4 v[216:219], v7, s[36:39], s53 offen nt
  buffer_load_dwordx4 v[220:223], v7, s[40:43], s53 offen nt
  v_and_b32 v72, v37, v88
  v_and_b32 v73, v37, v89
  v_and_b32 v74, v37, v90
  v_and_b32 v75, v37, v91
  v_and_b32 v76, v53, v88
  v_and_b32 v77, v53, v89
  v_and_b32 v78, v53, v90
  v_and_b32 v79, v53, v91
  s_nop 1
  v_mfma_f32_16x16x32_bf16 v[64:67], v[72:75], v[200:203], v[64:67]
  v_mfma_f32_16x16x32_bf16 v[68:71], v[76:79], v[200:203], v[68:71]
  v_mfma_f32_16x16x32_bf16 v[224:227], v[72:75], v[204:207], v[224:227]
  v_mfma_f32_16x16x32_bf16 v[228:231], v[76:79], v[204:207], v[228:231]
  s_lshl_b32 s54, s51, 7
  s_add_u32 s54, s54, 2945024
  s_mov_b64 exec, 31
  buffer_load_dwordx2 v[8:9], v19, s[32:35], s54 offen sc1
  s_mov_b64 exec, -1
  s_getreg_b32 s61, hwreg(HW_REG_XCC_ID)
  s_and_b32 s61, s61, 15
  s_waitcnt vmcnt(0)
  v_and_b32 v72, v38, v88
  v_and_b32 v73, v38, v89
  v_and_b32 v74, v38, v90
  v_and_b32 v75, v38, v91
  v_and_b32 v76, v54, v88
  v_and_b32 v77, v54, v89
  v_and_b32 v78, v54, v90
  v_and_b32 v79, v54, v91
  s_nop 1
  v_mfma_f32_16x16x32_bf16 v[64:67], v[72:75], v[208:211], v[64:67]
  v_mfma_f32_16x16x32_bf16 v[68:71], v[76:79], v[208:211], v[68:71]
  v_mfma_f32_16x16x32_bf16 v[224:227], v[72:75], v[212:215], v[224:227]
  v_mfma_f32_16x16x32_bf16 v[228:231], v[76:79], v[212:215], v[228:231]
  v_and_b32 v72, v39, v88
  v_and_b32 v73, v39, v89
  v_and_b32 v74, v39, v90
  v_and_b32 v75, v39, v91
  v_and_b32 v76, v55, v88
  v_and_b32 v77, v55, v89
  v_and_b32 v78, v55, v90
  v_and_b32 v79, v55, v91
  s_nop 1
  v_mfma_f32_16x16x32_bf16 v[64:67], v[72:75], v[216:219], v[64:67]
  v_mfma_f32_16x16x32_bf16 v[68:71], v[76:79], v[216:219], v[68:71]
  v_mfma_f32_16x16x32_bf16 v[224:227], v[72:75], v[220:223], v[224:227]
  v_mfma_f32_16x16x32_bf16 v[228:231], v[76:79], v[220:223], v[228:231]
  s_mul_i32 s53, s51, 10240
  s_add_u32 s53, s53, 1413120
  s_lshl_b32 s54, s52, 11
  s_add_u32 s54, s54, s53
  v_lshl_add_u32 v21, v20, 9, v18
  s_nop 3
  v_permlane32_swap_b32 v64, v66
  v_permlane32_swap_b32 v68, v70
  v_permlane32_swap_b32 v65, v67
  v_permlane32_swap_b32 v69, v71
  v_mov_b32 v81, s31
  v_mov_b32 v83, s31
  v_add_f32_dpp v80, v66, v64 row_shl:8 row_mask:0xf bank_mask:0xf
  v_add_f32_dpp v82, v67, v65 row_shl:8 row_mask:0xf bank_mask:0xf
  v_add_f32_dpp v80, v68, v70 row_shr:8 row_mask:0xf bank_mask:0xf
  v_add_f32_dpp v82, v69, v71 row_shr:8 row_mask:0xf bank_mask:0xf
  v_permlane32_swap_b32 v224, v226
  v_permlane32_swap_b32 v228, v230
  v_permlane32_swap_b32 v225, v227
  v_permlane32_swap_b32 v229, v231
  v_mov_b32 v85, s31
  v_mov_b32 v87, s31
  v_add_f32_dpp v84, v226, v224 row_shl:8 row_mask:0xf bank_mask:0xf
  v_add_f32_dpp v86, v227, v225 row_shl:8 row_mask:0xf bank_mask:0xf
  v_add_f32_dpp v84, v228, v230 row_shr:8 row_mask:0xf bank_mask:0xf
  v_add_f32_dpp v86, v229, v231 row_shr:8 row_mask:0xf bank_mask:0xf
  s_mov_b64 exec, 31
  v_xor_b32 v8, s61, v8
  v_xor_b32 v9, s31, v9
  v_or_b32 v8, v8, v9
  v_cmp_ne_u32 vcc, 0, v8
  s_mov_b64 exec, -1
  s_cbranch_vccnz L_G1_S
  buffer_store_dwordx4 v[80:83], v21, s[32:35], s54 offen
  buffer_store_dwordx4 v[84:87], v21, s[32:35], s54 offen offset:1024
  s_branch L_E1G
L_G1_S:
  buffer_store_dwordx4 v[80:83], v21, s[32:35], s54 offen sc1
  buffer_store_dwordx4 v[84:87], v21, s[32:35], s54 offen offset:1024 sc1
  s_branch L_E1G
L_G2:
  s_add_u32 s48, s2, 0
  s_and_b32 s48, s48, 7
  s_mul_i32 s56, s48, 3
  s_add_u32 s56, s56, s57
  s_getreg_b32 s61, hwreg(HW_REG_XCC_ID)
  s_and_b32 s61, s61, 15
  s_lshl_b32 s54, s56, 7
  s_lshl_b32 s53, s52, 4
  s_add_u32 s54, s54, s53
  s_add_u32 s54, s54, 2945024
  v_mov_b32 v8, s61
  v_mov_b32 v9, s31
  s_mov_b64 exec, 1
  buffer_store_dwordx2 v[8:9], v19, s[32:35], s54 offen sc1
  s_mov_b64 exec, -1
  s_mov_b32 s44, s20
  s_mov_b32 s45, s21
  s_mov_b32 s46, 1966080
  s_mov_b32 s47, 0x20000
  v_mul_u32_u24 v7, 1280, v5
  v_add_u32 v7, v7, v6
  s_mul_i32 s53, s56, 81920
  s_lshl_b32 s54, s52, 8
  s_add_u32 s53, s53, s54
  buffer_load_dwordx4 v[96:99], v7, s[44:47], s53 offen nt
  buffer_load_dwordx4 v[100:103], v7, s[44:47], s53 offen offset:128 nt
  s_add_u32 s53, s53, 10240
  buffer_load_dwordx4 v[104:107], v7, s[44:47], s53 offen nt
  buffer_load_dwordx4 v[108:111], v7, s[44:47], s53 offen offset:128 nt
  s_add_u32 s53, s53, 10240
  s_waitcnt vmcnt(2)
  buffer_load_dwordx4 v[112:115], v7, s[44:47], s53 offen nt
  buffer_load_dwordx4 v[116:119], v7, s[44:47], s53 offen offset:128 nt
  s_add_u32 s53, s53, 10240
  s_waitcnt vmcnt(2)
  buffer_load_dwordx4 v[120:123], v7, s[44:47], s53 offen nt
  buffer_load_dwordx4 v[124:127], v7, s[44:47], s53 offen offset:128 nt
  s_add_u32 s53, s53, 10240
  s_waitcnt vmcnt(2)
  buffer_load_dwordx4 v[128:131], v7, s[44:47], s53 offen nt
  buffer_load_dwordx4 v[132:135], v7, s[44:47], s53 offen offset:128 nt
  s_add_u32 s53, s53, 10240
  s_waitcnt vmcnt(2)
  buffer_load_dwordx4 v[136:139], v7, s[44:47], s53 offen nt
  buffer_load_dwordx4 v[140:143], v7, s[44:47], s53 offen offset:128 nt
  s_add_u32 s53, s53, 10240
  s_waitcnt vmcnt(2)
  buffer_load_dwordx4 v[144:147], v7, s[44:47], s53 offen nt
  buffer_load_dwordx4 v[148:151], v7, s[44:47], s53 offen offset:128 nt
  s_add_u32 s53, s53, 10240
  s_waitcnt vmcnt(2)
  buffer_load_dwordx4 v[152:155], v7, s[44:47], s53 offen nt
  buffer_load_dwordx4 v[156:159], v7, s[44:47], s53 offen offset:128 nt
  s_mul_i32 s53, s56, 10240
  s_add_u32 s53, s53, 1413120
  s_add_u32 s60, s53, 4096
  s_add_u32 s61, s53, 8192
  s_sleep 127
  s_sleep 127
  s_sleep 46
  s_mov_b32 s50, 0
L_G1POLL:
  buffer_load_dwordx4 v[160:163], v19, s[32:35], s53 offen offset:0 sc1
  buffer_load_dwordx4 v[164:167], v19, s[32:35], s53 offen offset:1024 sc1
  buffer_load_dwordx4 v[168:171], v19, s[32:35], s53 offen offset:2048 sc1
  buffer_load_dwordx4 v[172:175], v19, s[32:35], s53 offen offset:3072 sc1
  buffer_load_dwordx4 v[176:179], v19, s[32:35], s60 offen offset:0 sc1
  buffer_load_dwordx4 v[180:183], v19, s[32:35], s60 offen offset:1024 sc1
  buffer_load_dwordx4 v[184:187], v19, s[32:35], s60 offen offset:2048 sc1
  buffer_load_dwordx4 v[188:191], v19, s[32:35], s60 offen offset:3072 sc1
  buffer_load_dwordx4 v[192:195], v19, s[32:35], s61 offen offset:0 sc1
  buffer_load_dwordx4 v[196:199], v19, s[32:35], s61 offen offset:1024 sc1
  s_add_u32 s50, s50, 1
  s_waitcnt vmcnt(0)
  v_xor_b32 v8, s31, v161
  v_xor_b32 v9, s31, v165
  v_xor_b32 v10, s31, v169
  v_or3_b32 v8, v8, v9, v10
  v_xor_b32 v9, s31, v173
  v_xor_b32 v10, s31, v177
  v_or3_b32 v8, v8, v9, v10
  v_xor_b32 v9, s31, v181
  v_xor_b32 v10, s31, v185
  v_or3_b32 v8, v8, v9, v10
  v_xor_b32 v9, s31, v189
  v_xor_b32 v10, s31, v193
  v_or3_b32 v8, v8, v9, v10
  v_xor_b32 v9, s31, v197
  v_xor_b32 v10, s31, v163
  v_or3_b32 v8, v8, v9, v10
  v_xor_b32 v9, s31, v167
  v_xor_b32 v10, s31, v171
  v_or3_b32 v8, v8, v9, v10
  v_xor_b32 v9, s31, v175
  v_xor_b32 v10, s31, v179
  v_or3_b32 v8, v8, v9, v10
  v_xor_b32 v9, s31, v183
  v_xor_b32 v10, s31, v187
  v_or3_b32 v8, v8, v9, v10
  v_xor_b32 v9, s31, v191
  v_xor_b32 v10, s31, v195
  v_or3_b32 v8, v8, v9, v10
  v_xor_b32 v9, s31, v199
  v_or_b32 v8, v8, v9
  v_cmp_ne_u32 vcc, 0, v8
  s_cmp_gt_u32 s50, 0x40000
  s_cbranch_scc1 L_G1POLL_x
  s_cbranch_vccz L_G1POLL_x
  s_sleep 100
  s_branch L_G1POLL
L_G1POLL_x:
  v_add_f32 v160, v160, v168
  v_add_f32 v162, v162, v170
  v_add_f32 v164, v164, v172
  v_add_f32 v166, v166, v174
  v_add_f32 v160, v160, v176
  v_add_f32 v162, v162, v178
  v_add_f32 v164, v164, v180
  v_add_f32 v166, v166, v182
  v_add_f32 v160, v160, v184
  v_add_f32 v162, v162, v186
  v_add_f32 v164, v164, v188
  v_add_f32 v166, v166, v190
  v_add_f32 v160, v160, v192
  v_add_f32 v162, v162, v194
  v_add_f32 v164, v164, v196
  v_add_f32 v166, v166, v198
  v_cvt_pk_bf16_f32 v160, v160, v160
  v_and_b32 v160, 0xffff0000, v160
  v_cvt_pk_bf16_f32 v164, v164, v164
  v_and_b32 v164, 0xffff0000, v164
  v_mul_f32 v160, v160, v164
  v_cvt_pk_bf16_f32 v8, v160, v160
  v_cvt_pk_bf16_f32 v162, v162, v162
  v_and_b32 v162, 0xffff0000, v162
  v_cvt_pk_bf16_f32 v166, v166, v166
  v_and_b32 v166, 0xffff0000, v166
  v_mul_f32 v162, v162, v166
  v_cvt_pk_bf16_f32 v9, v162, v162
  v_lshlrev_b32 v21, 3, v0
  ds_write_b64 v21, v[8:9] offset:3328
  v_lshlrev_b32 v21, 2, v5
  ds_read_b32 v24, v21 offset:3328
  ds_read_b32 v25, v21 offset:3360
  ds_read_b32 v26, v21 offset:3392
  ds_read_b32 v27, v21 offset:3424
  ds_read_b32 v28, v21 offset:3456
  ds_read_b32 v29, v21 offset:3488
  ds_read_b32 v30, v21 offset:3520
  ds_read_b32 v31, v21 offset:3552
  ds_read_b32 v40, v21 offset:3584
  ds_read_b32 v41, v21 offset:3616
  ds_read_b32 v42, v21 offset:3648
  ds_read_b32 v43, v21 offset:3680
  ds_read_b32 v44, v21 offset:3712
  ds_read_b32 v45, v21 offset:3744
  ds_read_b32 v46, v21 offset:3776
  ds_read_b32 v47, v21 offset:3808
  s_waitcnt lgkmcnt(0)
  v_and_b32 v72, v24, v88
  v_and_b32 v73, v24, v89
  v_and_b32 v74, v24, v90
  v_and_b32 v75, v24, v91
  v_and_b32 v76, v40, v88
  v_and_b32 v77, v40, v89
  v_and_b32 v78, v40, v90
  v_and_b32 v79, v40, v91
  s_nop 1
  v_mfma_f32_16x16x32_bf16 v[64:67], v[72:75], v[96:99], 0
  v_mfma_f32_16x16x32_bf16 v[68:71], v[76:79], v[96:99], 0
  v_mfma_f32_16x16x32_bf16 v[224:227], v[72:75], v[100:103], 0
  v_mfma_f32_16x16x32_bf16 v[228:231], v[76:79], v[100:103], 0
  v_and_b32 v72, v25, v88
  v_and_b32 v73, v25, v89
  v_and_b32 v74, v25, v90
  v_and_b32 v75, v25, v91
  v_and_b32 v76, v41, v88
  v_and_b32 v77, v41, v89
  v_and_b32 v78, v41, v90
  v_and_b32 v79, v41, v91
  s_nop 1
  v_mfma_f32_16x16x32_bf16 v[64:67], v[72:75], v[104:107], v[64:67]
  v_mfma_f32_16x16x32_bf16 v[68:71], v[76:79], v[104:107], v[68:71]
  v_mfma_f32_16x16x32_bf16 v[224:227], v[72:75], v[108:111], v[224:227]
  v_mfma_f32_16x16x32_bf16 v[228:231], v[76:79], v[108:111], v[228:231]
  v_and_b32 v72, v26, v88
  v_and_b32 v73, v26, v89
  v_and_b32 v74, v26, v90
  v_and_b32 v75, v26, v91
  v_and_b32 v76, v42, v88
  v_and_b32 v77, v42, v89
  v_and_b32 v78, v42, v90
  v_and_b32 v79, v42, v91
  s_nop 1
  v_mfma_f32_16x16x32_bf16 v[64:67], v[72:75], v[112:115], v[64:67]
  v_mfma_f32_16x16x32_bf16 v[68:71], v[76:79], v[112:115], v[68:71]
  v_mfma_f32_16x16x32_bf16 v[224:227], v[72:75], v[116:119], v[224:227]
  v_mfma_f32_16x16x32_bf16 v[228:231], v[76:79], v[116:119], v[228:231]
  v_and_b32 v72, v27, v88
  v_and_b32 v73, v27, v89
  v_and_b32 v74, v27, v90
  v_and_b32 v75, v27, v91
  v_and_b32 v76, v43, v88
  v_and_b32 v77, v43, v89
  v_and_b32 v78, v43, v90
  v_and_b32 v79, v43, v91
  s_nop 1
  v_mfma_f32_16x16x32_bf16 v[64:67], v[72:75], v[120:123], v[64:67]
  v_mfma_f32_16x16x32_bf16 v[68:71], v[76:79], v[120:123], v[68:71]
  v_mfma_f32_16x16x32_bf16 v[224:227], v[72:75], v[124:127], v[224:227]
  v_mfma_f32_16x16x32_bf16 v[228:231], v[76:79], v[124:127], v[228:231]
  v_and_b32 v72, v28, v88
  v_and_b32 v73, v28, v89
  v_and_b32 v74, v28, v90
  v_and_b32 v75, v28, v91
  v_and_b32 v76, v44, v88
  v_and_b32 v77, v44, v89
  v_and_b32 v78, v44, v90
  v_and_b32 v79, v44, v91
  s_nop 1
  v_mfma_f32_16x16x32_bf16 v[64:67], v[72:75], v[128:131], v[64:67]
  v_mfma_f32_16x16x32_bf16 v[68:71], v[76:79], v[128:131], v[68:71]
  v_mfma_f32_16x16x32_bf16 v[224:227], v[72:75], v[132:135], v[224:227]
  v_mfma_f32_16x16x32_bf16 v[228:231], v[76:79], v[132:135], v[228:231]
  v_and_b32 v72, v29, v88
  v_and_b32 v73, v29, v89
  v_and_b32 v74, v29, v90
  v_and_b32 v75, v29, v91
  v_and_b32 v76, v45, v88
  v_and_b32 v77, v45, v89
  v_and_b32 v78, v45, v90
  v_and_b32 v79, v45, v91
  s_nop 1
  v_mfma_f32_16x16x32_bf16 v[64:67], v[72:75], v[136:139], v[64:67]
  v_mfma_f32_16x16x32_bf16 v[68:71], v[76:79], v[136:139], v[68:71]
  v_mfma_f32_16x16x32_bf16 v[224:227], v[72:75], v[140:143], v[224:227]
  v_mfma_f32_16x16x32_bf16 v[228:231], v[76:79], v[140:143], v[228:231]
  v_and_b32 v72, v30, v88
  v_and_b32 v73, v30, v89
  v_and_b32 v74, v30, v90
  v_and_b32 v75, v30, v91
  v_and_b32 v76, v46, v88
  v_and_b32 v77, v46, v89
  v_and_b32 v78, v46, v90
  v_and_b32 v79, v46, v91
  s_nop 1
  v_mfma_f32_16x16x32_bf16 v[64:67], v[72:75], v[144:147], v[64:67]
  v_mfma_f32_16x16x32_bf16 v[68:71], v[76:79], v[144:147], v[68:71]
  v_mfma_f32_16x16x32_bf16 v[224:227], v[72:75], v[148:151], v[224:227]
  v_mfma_f32_16x16x32_bf16 v[228:231], v[76:79], v[148:151], v[228:231]
  v_and_b32 v72, v31, v88
  v_and_b32 v73, v31, v89
  v_and_b32 v74, v31, v90
  v_and_b32 v75, v31, v91
  v_and_b32 v76, v47, v88
  v_and_b32 v77, v47, v89
  v_and_b32 v78, v47, v90
  v_and_b32 v79, v47, v91
  s_nop 1
  v_mfma_f32_16x16x32_bf16 v[64:67], v[72:75], v[152:155], v[64:67]
  v_mfma_f32_16x16x32_bf16 v[68:71], v[76:79], v[152:155], v[68:71]
  v_mfma_f32_16x16x32_bf16 v[224:227], v[72:75], v[156:159], v[224:227]
  v_mfma_f32_16x16x32_bf16 v[228:231], v[76:79], v[156:159], v[228:231]
  v_bfe_u32 v21, v0, 1, 2
  v_mul_u32_u24 v21, 6144, v21
  v_and_b32 v22, 0x7f, v18
  v_lshl_add_u32 v21, v22, 1, v21
  v_lshl_add_u32 v21, v20, 4, v21
  s_mul_i32 s53, s52, 49152
  s_lshl_b32 s54, s56, 8
  s_add_u32 s53, s53, s54
  s_add_u32 s53, s53, 1904640
  s_add_u32 s54, s53, 24576
  v_permlane32_swap_b32 v64, v66
  v_permlane32_swap_b32 v68, v70
  v_permlane32_swap_b32 v65, v67
  v_permlane32_swap_b32 v69, v71
  v_mov_b32 v81, s31
  v_mov_b32 v83, s31
  v_add_f32_dpp v80, v66, v64 row_shl:8 row_mask:0xf bank_mask:0xf
  v_add_f32_dpp v82, v70, v68 row_shl:8 row_mask:0xf bank_mask:0xf
  v_add_f32_dpp v80, v65, v67 row_shr:8 row_mask:0xf bank_mask:0xf
  v_add_f32_dpp v82, v69, v71 row_shr:8 row_mask:0xf bank_mask:0xf
  v_permlane32_swap_b32 v224, v226
  v_permlane32_swap_b32 v228, v230
  v_permlane32_swap_b32 v225, v227
  v_permlane32_swap_b32 v229, v231
  v_mov_b32 v85, s31
  v_mov_b32 v87, s31
  v_add_f32_dpp v84, v226, v224 row_shl:8 row_mask:0xf bank_mask:0xf
  v_add_f32_dpp v86, v230, v228 row_shl:8 row_mask:0xf bank_mask:0xf
  v_add_f32_dpp v84, v225, v227 row_shr:8 row_mask:0xf bank_mask:0xf
  v_add_f32_dpp v86, v229, v231 row_shr:8 row_mask:0xf bank_mask:0xf
  buffer_store_dwordx4 v[80:83], v21, s[32:35], s53 offen sc1
  buffer_store_dwordx4 v[84:87], v21, s[32:35], s54 offen sc1
L_E1G:
  s_lshr_b32 s55, s3, 1
  s_lshl_b32 s53, s58, 13
  s_add_u32 s53, s53, 823296
  s_lshl_b32 s54, s55, 12
  s_add_u32 s53, s53, s54
  s_mul_i32 s54, s55, 384
  v_bfe_u32 v21, v0, 2, 2
  v_bfe_u32 v22, v0, 4, 1
  v_lshl_add_u32 v21, v21, 1, v22
  v_and_b32 v22, 0x23, v0
  v_lshl_add_u32 v21, v21, 2, v22
  v_lshl_add_u32 v21, v21, 1, s54
  s_barrier
  s_mov_b32 s50, 0
L_E1POLL:
  buffer_load_dwordx4 v[64:67], v19, s[32:35], s53 offen offset:0 sc1
  buffer_load_dwordx4 v[68:71], v19, s[32:35], s53 offen offset:1024 sc1
  buffer_load_dwordx4 v[72:75], v19, s[32:35], s53 offen offset:2048 sc1
  buffer_load_dwordx4 v[76:79], v19, s[32:35], s53 offen offset:3072 sc1
  s_add_u32 s50, s50, 1
  s_waitcnt vmcnt(0)
  v_xor_b32 v8, s31, v67
  v_xor_b32 v9, s31, v71
  v_xor_b32 v10, s31, v75
  v_or3_b32 v8, v8, v9, v10
  v_xor_b32 v9, s31, v79
  v_or_b32 v8, v8, v9
  v_cmp_ne_u32 vcc, 0, v8
  s_cmp_gt_u32 s50, 0x40000
  s_cbranch_scc1 L_E1POLL_x
  s_cbranch_vccnz L_E1POLL
L_E1POLL_x:
  v_add_f32 v64, v64, v68
  v_add_f32 v72, v72, v76
  v_add_f32 v65, v65, v69
  v_add_f32 v73, v73, v77
  v_add_f32 v66, v66, v70
  v_add_f32 v74, v74, v78
  v_add_f32 v64, v64, v72
  v_add_f32 v65, v65, v73
  v_add_f32 v66, v66, v74
  v_cvt_pk_bf16_f32 v64, v64, v64
  ds_write_b16 v21, v64 offset:2560
  v_cvt_pk_bf16_f32 v65, v65, v65
  ds_write_b16 v21, v65 offset:2688
  v_cvt_pk_bf16_f32 v66, v66, v66
  ds_write_b16 v21, v66 offset:2816
  s_waitcnt lgkmcnt(0)
  s_barrier
  s_branch L_fin
L_H2_PRE:
  s_cmp_lt_u32 s2, 216
  s_cbranch_scc1 L_H2_IDLE
  s_cmp_ge_u32 s2, 256
  s_cbranch_scc1 L_H2_IDLE
  s_sub_u32 s55, s2, 216
  v_bfe_u32 v21, v0, 4, 1
  v_mul_u32_u24 v21, 1280, v21
  v_and_b32 v22, 15, v0
  v_lshl_add_u32 v21, v22, 1, v21
  s_lshl_b32 s54, s55, 5
  v_add_u32 v92, s54, v21
  global_load_ushort v93, v92, s[4:5]
  s_mul_i32 s53, s55, 6144
  s_add_u32 s53, s53, 1904640
  s_add_u32 s60, s53, 4096
  s_sleep 127
  s_sleep 127
  s_sleep 127
  s_sleep 99
  s_mov_b32 s50, 0
L_G2POLL:
  buffer_load_dwordx4 v[96:99], v19, s[32:35], s53 offen offset:0 sc1
  buffer_load_dwordx4 v[100:103], v19, s[32:35], s53 offen offset:1024 sc1
  buffer_load_dwordx4 v[104:107], v19, s[32:35], s53 offen offset:2048 sc1
  buffer_load_dwordx4 v[108:111], v19, s[32:35], s53 offen offset:3072 sc1
  buffer_load_dwordx4 v[112:115], v19, s[32:35], s60 offen offset:0 sc1
  buffer_load_dwordx4 v[116:119], v19, s[32:35], s60 offen offset:1024 sc1
  s_add_u32 s50, s50, 1
  s_waitcnt vmcnt(0)
  v_xor_b32 v8, s31, v97
  v_xor_b32 v9, s31, v101
  v_xor_b32 v10, s31, v105
  v_or3_b32 v8, v8, v9, v10
  v_xor_b32 v9, s31, v109
  v_xor_b32 v10, s31, v113
  v_or3_b32 v8, v8, v9, v10
  v_xor_b32 v9, s31, v117
  v_xor_b32 v10, s31, v99
  v_or3_b32 v8, v8, v9, v10
  v_xor_b32 v9, s31, v103
  v_xor_b32 v10, s31, v107
  v_or3_b32 v8, v8, v9, v10
  v_xor_b32 v9, s31, v111
  v_xor_b32 v10, s31, v115
  v_or3_b32 v8, v8, v9, v10
  v_xor_b32 v9, s31, v119
  v_or_b32 v8, v8, v9
  v_cmp_ne_u32 vcc, 0, v8
  s_cmp_gt_u32 s50, 0x40000
  s_cbranch_scc1 L_G2POLL_x
  s_cbranch_vccz L_G2POLL_x
  s_sleep 64
  s_branch L_G2POLL
L_G2POLL_x:
  v_add_f32 v96, v96, v100
  v_add_f32 v98, v98, v102
  v_add_f32 v96, v96, v104
  v_add_f32 v98, v98, v106
  v_add_f32 v96, v96, v108
  v_add_f32 v98, v98, v110
  v_add_f32 v96, v96, v112
  v_add_f32 v98, v98, v114
  v_add_f32 v96, v96, v116
  v_add_f32 v98, v98, v118
  s_nop 1
  v_permlane16_swap_b32 v96, v98
  v_add_f32 v96, v96, v98
  v_mov_b32 v98, v96
  s_nop 1
  v_permlane32_swap_b32 v98, v96
  v_add_f32 v96, v96, v98
  v_cvt_pk_bf16_f32 v96, v96, v96
  v_and_b32 v96, 0xffff0000, v96
  v_mul_f32 v21, 0xbfb8aa3b, v96
  v_exp_f32 v21, v21
  s_nop 0
  v_add_f32 v21, 1.0, v21
  v_rcp_f32 v21, v21
  s_nop 0
  v_mul_f32 v94, v96, v21
  v_cvt_pk_bf16_f32 v94, v94, v94
  v_and_b32 v94, 0xffff0000, v94
  v_lshlrev_b32 v93, 16, v93
  s_lshl_b32 s53, s55, 13
  s_add_u32 s53, s53, 1085440
  s_add_u32 s60, s53, 4096
  s_barrier
  s_barrier
  s_mov_b32 s50, 0
L_E2POLL:
  buffer_load_dwordx4 v[96:99], v19, s[32:35], s53 offen offset:0 sc1
  buffer_load_dwordx4 v[100:103], v19, s[32:35], s53 offen offset:1024 sc1
  buffer_load_dwordx4 v[104:107], v19, s[32:35], s53 offen offset:2048 sc1
  buffer_load_dwordx4 v[108:111], v19, s[32:35], s53 offen offset:3072 sc1
  buffer_load_dwordx4 v[112:115], v19, s[32:35], s60 offen offset:0 sc1
  buffer_load_dwordx4 v[116:119], v19, s[32:35], s60 offen offset:1024 sc1
  buffer_load_dwordx4 v[120:123], v19, s[32:35], s60 offen offset:2048 sc1
  buffer_load_dwordx4 v[124:127], v19, s[32:35], s60 offen offset:3072 sc1
  s_add_u32 s50, s50, 1
  s_waitcnt vmcnt(0)
  v_xor_b32 v8, s31, v97
  v_xor_b32 v9, s31, v101
  v_xor_b32 v10, s31, v105
  v_or3_b32 v8, v8, v9, v10
  v_xor_b32 v9, s31, v109
  v_xor_b32 v10, s31, v113
  v_or3_b32 v8, v8, v9, v10
  v_xor_b32 v9, s31, v117
  v_xor_b32 v10, s31, v121
  v_or3_b32 v8, v8, v9, v10
  v_xor_b32 v9, s31, v125
  v_xor_b32 v10, s31, v99
  v_or3_b32 v8, v8, v9, v10
  v_xor_b32 v9, s31, v103
  v_xor_b32 v10, s31, v107
  v_or3_b32 v8, v8, v9, v10
  v_xor_b32 v9, s31, v111
  v_xor_b32 v10, s31, v115
  v_or3_b32 v8, v8, v9, v10
  v_xor_b32 v9, s31, v119
  v_xor_b32 v10, s31, v123
  v_or3_b32 v8, v8, v9, v10
  v_xor_b32 v9, s31, v127
  v_or_b32 v8, v8, v9
  v_cmp_ne_u32 vcc, 0, v8
  s_cmp_gt_u32 s50, 0x40000
  s_cbranch_scc1 L_E2POLL_x
  s_cbranch_vccnz L_E2POLL
L_E2POLL_x:
  v_add_f32 v96, v96, v100
  v_add_f32 v98, v98, v102
  v_add_f32 v96, v96, v104
  v_add_f32 v98, v98, v106
  v_add_f32 v96, v96, v108
  v_add_f32 v98, v98, v110
  v_add_f32 v96, v96, v112
  v_add_f32 v98, v98, v114
  v_add_f32 v96, v96, v116
  v_add_f32 v98, v98, v118
  v_add_f32 v96, v96, v120
  v_add_f32 v98, v98, v122
  v_add_f32 v96, v96, v124
  v_add_f32 v98, v98, v126
  s_nop 1
  v_permlane16_swap_b32 v96, v98
  v_add_f32 v96, v96, v98
  v_mov_b32 v98, v96
  s_nop 1
  v_permlane32_swap_b32 v98, v96
  v_add_f32 v96, v96, v98
  v_cvt_pk_bf16_f32 v96, v96, v96
  v_and_b32 v96, 0xffff0000, v96
  v_mul_f32 v96, v96, v94
  v_cvt_pk_bf16_f32 v96, v96, v96
  v_and_b32 v96, 0xffff0000, v96
  v_add_f32 v96, v96, v93
  v_cvt_pk_bf16_f32 v96, v96, v96
  s_mov_b32 exec_hi, 0
  global_store_short v92, v96, s[22:23]
  s_cmp_eq_u32 s55, 0
  s_cbranch_scc0 L_fin
  s_mov_b32 exec_lo, 1
  v_mov_b32 v21, s31
  v_mov_b32 v22, 0
  buffer_store_dword v21, v22, s[32:35], 0 offen
  s_branch L_fin
L_H2_IDLE:
  s_barrier
  s_barrier
  s_branch L_fin
L_H0:
  v_and_b32 v21, 3, v0
  v_lshlrev_b32 v21, 4, v21
  s_mov_b32 s50, 0
L_MLPOLL:
  s_sleep 8
  ds_read_b128 v[24:27], v21 offset:2432
  s_add_u32 s50, s50, 1
  s_waitcnt lgkmcnt(0)
  v_cmp_eq_u32 vcc, 0, v26
  s_cmp_gt_u32 s50, 0x40000
  s_cbranch_scc1 L_MLPOLL_x
  s_cbranch_vccnz L_MLPOLL
L_MLPOLL_x:
  v_max_f32_dpp v28, v24, v24 quad_perm:[1,0,3,2] row_mask:0xf bank_mask:0xf
  s_nop 1
  v_max_f32_dpp v28, v28, v28 quad_perm:[2,3,0,1] row_mask:0xf bank_mask:0xf
  v_sub_f32 v24, v24, v28
  v_mul_f32 v24, 0x3fb8aa3b, v24
  v_exp_f32 v24, v24
  s_nop 0
  v_mul_f32 v25, v24, v25
  s_nop 1
  v_add_f32_dpp v29, v25, v25 quad_perm:[1,0,3,2] row_mask:0xf bank_mask:0xf
  s_nop 1
  v_add_f32_dpp v29, v29, v29 quad_perm:[2,3,0,1] row_mask:0xf bank_mask:0xf
  v_mov_b32 v32, v28
  v_mov_b32 v33, v29
  v_mov_b32 v34, s57
  v_mov_b32 v35, s31
  s_lshl_b32 s53, s28, 10
  s_add_u32 s53, s53, 4096
  s_lshl_b32 s54, s29, 7
  s_add_u32 s54, s54, s53
  s_waitcnt vmcnt(0)
  s_mov_b64 exec, 0xff
  s_cmp_eq_u32 s57, 1
  s_cbranch_scc1 L_LX_F
  buffer_store_dwordx4 v[32:35], v19, s[32:35], s54 offen sc1
  s_branch L_LX_G
L_LX_F:
  buffer_store_dwordx4 v[32:35], v19, s[32:35], s54 offen
L_LX_G:
  s_mov_b64 exec, -1
  s_lshl_b32 s60, s30, 9
  s_add_u32 s53, s53, s60
  v_and_b32 v22, 3, v0
  v_lshlrev_b32 v22, 7, v22
  s_sleep 20
  s_mov_b32 s50, 0
L_LXPOLL:
  buffer_load_dwordx4 v[36:39], v22, s[32:35], s53 offen sc1
  s_add_u32 s50, s50, 1
  s_waitcnt vmcnt(0)
  v_xor_b32 v8, s31, v39
  v_cmp_ne_u32 vcc, 0, v8
  s_cmp_gt_u32 s50, 0x40000
  s_cbranch_scc1 L_LXPOLL_x
  s_cbranch_vccz L_LXPOLL_x
  s_sleep 32
  s_branch L_LXPOLL
L_LXPOLL_x:
  v_max_f32_dpp v28, v36, v36 quad_perm:[1,0,3,2] row_mask:0xf bank_mask:0xf
  s_nop 1
  v_max_f32_dpp v28, v28, v28 quad_perm:[2,3,0,1] row_mask:0xf bank_mask:0xf
  v_sub_f32 v36, v36, v28
  v_mul_f32 v36, 0x3fb8aa3b, v36
  v_exp_f32 v36, v36
  s_lshl_b32 s60, s30, 2
  v_mul_f32 v36, v36, v37
  s_nop 1
  v_add_f32_dpp v29, v36, v36 quad_perm:[1,0,3,2] row_mask:0xf bank_mask:0xf
  s_nop 1
  v_add_f32_dpp v29, v29, v29 quad_perm:[2,3,0,1] row_mask:0xf bank_mask:0xf
  v_sub_f32 v32, v32, v28
  v_rcp_f32 v29, v29
  v_mul_f32 v32, 0x3fb8aa3b, v32
  v_exp_f32 v32, v32
  v_mul_f32 v24, v24, v29
  v_mul_f32 v24, v24, v32
  s_nop 1
  v_mov_b32_dpp v28, v24 quad_perm:[0,0,0,0] row_mask:0xf bank_mask:0xf
  v_mov_b32_dpp v29, v24 quad_perm:[1,1,1,1] row_mask:0xf bank_mask:0xf
  v_mov_b32_dpp v30, v24 quad_perm:[2,2,2,2] row_mask:0xf bank_mask:0xf
  v_mov_b32_dpp v31, v24 quad_perm:[3,3,3,3] row_mask:0xf bank_mask:0xf
  v_lshlrev_b32 v21, 2, v0
  s_lshl_b32 s54, s28, 13
  s_add_u32 s54, s54, 823296
  s_lshl_b32 s53, s29, 10
  s_add_u32 s54, s54, s53
  v_mov_b32 v35, s31
  s_mov_b32 s55, 4
  s_barrier
  s_cmp_eq_u32 s57, 1
  ds_read2st64_b32 v[40:41], v21 offset0:15 offset1:16
  ds_read2st64_b32 v[42:43], v21 offset0:17 offset1:18
  ds_read2st64_b32 v[44:45], v21 offset0:19 offset1:20
  ds_read2st64_b32 v[46:47], v21 offset0:21 offset1:22
  ds_read2st64_b32 v[48:49], v21 offset0:23 offset1:24
  ds_read2st64_b32 v[50:51], v21 offset0:25 offset1:26
  ds_read2st64_b32 v[52:53], v21 offset0:27 offset1:28
  ds_read2st64_b32 v[54:55], v21 offset0:29 offset1:30
  ds_read2st64_b32 v[56:57], v21 offset0:31 offset1:32
  ds_read2st64_b32 v[58:59], v21 offset0:33 offset1:34
  ds_read2st64_b32 v[60:61], v21 offset0:35 offset1:36
  ds_read2st64_b32 v[62:63], v21 offset0:37 offset1:38
  s_waitcnt lgkmcnt(9)
  v_mul_f32 v32, v28, v40
  v_mul_f32 v33, v28, v41
  v_mul_f32 v34, v28, v42
  v_fmac_f32 v32, v28, v43
  v_fmac_f32 v33, v28, v44
  v_fmac_f32 v34, v28, v45
  s_waitcnt lgkmcnt(6)
  v_fmac_f32 v32, v29, v46
  v_fmac_f32 v33, v29, v47
  v_fmac_f32 v34, v29, v48
  v_fmac_f32 v32, v29, v49
  v_fmac_f32 v33, v29, v50
  v_fmac_f32 v34, v29, v51
  s_waitcnt lgkmcnt(3)
  v_fmac_f32 v32, v30, v52
  v_fmac_f32 v33, v30, v53
  v_fmac_f32 v34, v30, v54
  v_fmac_f32 v32, v30, v55
  v_fmac_f32 v33, v30, v56
  v_fmac_f32 v34, v30, v57
  s_waitcnt lgkmcnt(0)
  v_fmac_f32 v32, v31, v58
  v_fmac_f32 v33, v31, v59
  v_fmac_f32 v34, v31, v60
  v_fmac_f32 v32, v31, v61
  v_fmac_f32 v33, v31, v62
  v_fmac_f32 v34, v31, v63
  s_cbranch_scc1 L_E1_FAST
  buffer_store_dwordx4 v[32:35], v19, s[32:35], s54 offen sc1
  s_branch L_WO_PRE
L_E1_FAST:
  buffer_store_dwordx4 v[32:35], v19, s[32:35], s54 offen
  s_branch L_WO_PRE
L_code_end:
  s_endpgm
.section .rodata,"a"
.p2align 6
.amdhsa_kernel recurrent_scan__gqa_block_cached__glu_gated_bilinear__decode_kernel
  .amdhsa_next_free_vgpr 256
  .amdhsa_next_free_sgpr 96
  .amdhsa_accum_offset 256
  .amdhsa_group_segment_fixed_size 0
  .amdhsa_kernarg_size 96
  .amdhsa_user_sgpr_count 2
  .amdhsa_user_sgpr_kernarg_segment_ptr 1
  .amdhsa_system_sgpr_workgroup_id_x 1
  .amdhsa_float_denorm_mode_32 3
.end_amdhsa_kernel
```
